```python
import torch

def _softmax(x, axis=-1):
    return torch.softmax(x, dim=axis)
def _gelu(x):
    return torch.nn.functional.gelu(x, approximate="tanh")
def _silu(x):
    return torch.nn.functional.silu(x)
def _sigmoid(x):
    return torch.sigmoid(x)
def _layernorm(x, axis=-1, eps=1e-5):
    m = x.mean(dim=axis, keepdim=True)
    v = x.var(dim=axis, keepdim=True, unbiased=False)
    return (x - m) / torch.sqrt(v + eps)
def _scatter_add(tgt, idx, src, axis=0):
    return tgt.clone().index_add_(axis, idx, src)
def _segment_sum(src, seg, n):
    out = torch.zeros((n,) + src.shape[1:], dtype=src.dtype)
    return out.index_add_(0, seg, src)
def _pad(x, pw):
    flat = tuple(v for pair in reversed(pw) for v in pair)
    return torch.nn.functional.pad(x, flat)

kernel_name = 'standalone__window_attn_swin__vision'

def setup_inputs():

    _w = (lambda a: (lambda t: t.to(torch.bfloat16) if t.is_floating_point() else t)(torch.as_tensor(a)))
    H = W = 224
    C = 192
    ws = 7
    nh = 4
    shift = ws // 2
    coords = torch.stack(torch.meshgrid(torch.arange(ws), torch.arange(ws), indexing='ij'), 0).reshape(2, -1)
    rel = coords[:, :, None] - coords[:, None, :]
    rel[0] += ws - 1
    rel[1] += ws - 1
    rel[0] *= 2 * ws - 1
    rp_idx = rel.sum(0).to(torch.int64)
    img_mask = torch.zeros((1, H, W, 1), dtype=float)
    cnt = 0
    for hs in (slice(0, H - ws), slice(H - ws, H - shift), slice(H - shift, H)):
        for vs in (slice(0, W - ws), slice(W - ws, W - shift), slice(W - shift, W)):
            img_mask[:, hs, vs, :] = cnt
            cnt += 1
    mw = img_mask.reshape(1, H // ws, ws, W // ws, ws, 1).permute(0, 1, 3, 2, 4, 5).reshape(-1, ws * ws)
    am = mw[:, :, None] - mw[:, None, :]
    attn_mask = torch.where(am != 0, -100.0, 0.0).to(float)
    return {
        "x": _w((lambda *s: torch.randn(*s, dtype=torch.bfloat16) * 1.6)(1, H, W, C)),
        "wqkv": _w((lambda *s: torch.randn(*s, dtype=torch.bfloat16) * 1.6)(C, 3 * C) * 0.02),
        "wo": _w((lambda *s: torch.randn(*s, dtype=torch.bfloat16) * 0.05)(C, C) * 0.02),
        "rpb": _w((lambda *s: torch.randn(*s, dtype=torch.bfloat16) * 0.2)((2 * ws - 1) * (2 * ws - 1), nh)),
        "rp_idx": _w(rp_idx),
        "attn_mask": _w(attn_mask),
    }

def reference(x, wqkv, wo, rpb, rp_idx, attn_mask):
    B, H, W, C = x.shape
    N = rp_idx.shape[0]
    ws = int(round(N ** 0.5))
    nh = rpb.shape[-1]
    hd = C // nh
    shift = ws // 2
    xs = torch.roll(x, (-shift, -shift), (1, 2))
    nWh = H // ws
    nWw = W // ws
    xw = (lambda x, *d: x.permute(*d))(xs.reshape(B, nWh, ws, nWw, ws, C), 0, 1, 3, 2, 4, 5).reshape(B * nWh * nWw, N, C)
    qkv = (lambda x, *d: x.permute(*d))(torch.einsum('wnc,cd->wnd', xw, wqkv).reshape(-1, N, 3, nh, hd), 2, 0, 3, 1, 4)
    q, k, v = qkv[0], qkv[1], qkv[2]
    attn = torch.einsum('whid,whjd->whij', q, k) * (hd ** -0.5)
    bias = (lambda x, *d: x.permute(*d))(rpb[rp_idx.reshape(-1)].reshape(N, N, nh), 2, 0, 1)
    attn = attn + bias[None, :, :, :]
    attn = (attn.reshape(B, nWh * nWw, nh, N, N) + attn_mask[None, :, None, :, :]).reshape(-1, nh, N, N)
    attn = _softmax(attn, axis=-1)
    out = (lambda x, *d: x.permute(*d))(torch.einsum('whij,whjd->whid', attn, v), 0, 2, 1, 3).reshape(-1, N, C)
    out = torch.einsum('wnc,cd->wnd', out, wo)
    out = (lambda x, *d: x.permute(*d))(out.reshape(B, nWh, nWw, ws, ws, C), 0, 1, 3, 2, 4, 5).reshape(B, H, W, C)
    return torch.roll(out, (shift, shift), (1, 2))
```

```asm
; @launch grid=(256,1,1) block=(256,1,1) lds=158720
.amdgcn_target "amdgcn-amd-amdhsa--gfx950"
.text
.globl standalone__window_attn_swin__vision_kernel
.p2align 8
.type standalone__window_attn_swin__vision_kernel,@function
standalone__window_attn_swin__vision_kernel:
    s_cmp_ge_u32 s2, 256
    s_cbranch_scc1 L_end
    s_load_dwordx2 s[16:17], s[0:1], 0
    s_load_dwordx2 s[20:21], s[0:1], 8
    s_load_dwordx2 s[24:25], s[0:1], 16
    s_load_dwordx2 s[28:29], s[0:1], 24
    s_load_dwordx2 s[32:33], s[0:1], 48
    s_load_dwordx2 s[14:15], s[0:1], 56
    v_lshrrev_b32 v1, 6, v0
    v_and_b32 v64, 63, v0
    v_readfirstlane_b32 s36, v1
    s_getpc_b64 s[4:5]
L_pc:
    s_lshr_b32 s6, s2, 3
    s_and_b32 s6, s6, 31
    s_mul_i32 s6, s6, 10
    v_add_u32 v2, s6, v64
    v_lshlrev_b32 v2, 7, v2
    v_min_u32 v2, L_end-L_pc, v2
    s_mov_b32 exec_lo, 0x3ff
    s_mov_b32 exec_hi, 0
    global_load_dword v3, v2, s[4:5]
    s_mov_b64 exec, -1
    s_mov_b32 s18, 0x1260000
    s_mov_b32 s19, 0x20000
    s_lshr_b32 s37, s2, 3
    s_mul_i32 s40, s37, 602112
    s_and_b32 s47, s2, 7
    s_mul_i32 s48, s47, 10752
    s_add_u32 s40, s40, s48
    s_add_u32 s40, s40, 259200
    s_mul_i32 s52, s36, 288
    s_mul_i32 s45, s36, 4608
    s_movk_i32 s89, 1024
    s_movk_i32 s78, -24
    s_movk_i32 s79, 384
    s_mov_b32 s80, 83328
    v_add_u32 v96, s52, v64
    v_add_u32 v97, 64, v96
    v_add_u32 v98, 128, v96
    v_add_u32 v99, 192, v96
    v_add_u32 v100, 256, v96
    v_mul_u32_u24 v32, 2731, v96
    v_mul_u32_u24 v33, 2731, v97
    v_mul_u32_u24 v34, 2731, v98
    v_mul_u32_u24 v35, 2731, v99
    v_mul_u32_u24 v36, 2731, v100
    v_lshrrev_b32 v32, 16, v32
    v_lshrrev_b32 v33, 16, v33
    v_lshrrev_b32 v34, 16, v34
    v_lshrrev_b32 v35, 16, v35
    v_lshrrev_b32 v36, 16, v36
    v_mad_i32_i24 v96, v32, s78, v96
    v_mad_i32_i24 v97, v33, s78, v97
    v_mad_i32_i24 v98, v34, s78, v98
    v_mad_i32_i24 v99, v35, s78, v99
    v_mad_i32_i24 v100, v36, s78, v100
    v_bfe_u32 v111, v32, 1, 3
    v_bfe_u32 v112, v33, 1, 3
    v_bfe_u32 v113, v34, 1, 3
    v_bfe_u32 v114, v35, 1, 3
    v_bfe_u32 v115, v36, 1, 3
    v_mul_u32_u24 v40, 37, v32
    v_mul_u32_u24 v41, 37, v33
    v_mul_u32_u24 v42, 37, v34
    v_mul_u32_u24 v43, 37, v35
    v_mul_u32_u24 v44, 37, v36
    v_xor_b32 v96, v96, v111
    v_xor_b32 v97, v97, v112
    v_xor_b32 v98, v98, v113
    v_xor_b32 v99, v99, v114
    v_xor_b32 v100, v100, v115
    v_lshrrev_b32 v40, 8, v40
    v_lshrrev_b32 v41, 8, v41
    v_lshrrev_b32 v42, 8, v42
    v_lshrrev_b32 v43, 8, v43
    v_lshrrev_b32 v44, 8, v44
    v_lshl_add_u32 v236, v96, 4, s40
    v_lshl_add_u32 v237, v97, 4, s40
    v_lshl_add_u32 v238, v98, 4, s40
    v_lshl_add_u32 v239, v99, 4, s40
    v_lshl_add_u32 v240, v100, 4, s40
    v_mad_u32_u24 v236, v32, s79, v236
    v_mad_u32_u24 v237, v33, s79, v237
    v_mad_u32_u24 v238, v34, s79, v238
    v_mad_u32_u24 v239, v35, s79, v239
    v_mad_u32_u24 v240, v36, s79, v240
    v_mad_u32_u24 v236, v40, s80, v236
    v_mad_u32_u24 v237, v41, s80, v237
    v_mad_u32_u24 v238, v42, s80, v238
    v_mad_u32_u24 v239, v43, s80, v239
    v_mad_u32_u24 v240, v44, s80, v240
    v_subrev_u32 v111, 0x1260000, v236
    v_subrev_u32 v112, 0x1260000, v237
    v_subrev_u32 v113, 0x1260000, v238
    v_subrev_u32 v114, 0x1260000, v239
    v_subrev_u32 v115, 0x1260000, v240
    v_min_u32 v236, v236, v111
    v_min_u32 v237, v237, v112
    v_min_u32 v238, v238, v113
    v_min_u32 v239, v239, v114
    v_min_u32 v240, v240, v115
    s_mov_b32 s30, 0x548
    s_mov_b32 s31, 0x20000
    s_lshl_b32 s49, s36, 1
    v_lshl_add_u32 v117, v64, 3, s49
    s_waitcnt lgkmcnt(0)
    buffer_load_ushort v80, v117, s[28:31], 0 offen offset:0
    buffer_load_ushort v81, v117, s[28:31], 0 offen offset:512
    buffer_load_ushort v82, v117, s[28:31], 0 offen offset:1024
    s_mov_b32 m0, s45
    s_nop 0
    buffer_load_dwordx4 v236, s[16:19], 0 offen nt lds
    s_mov_b32 s22, 0x36000
    s_mov_b32 s23, 0x20000
    s_mov_b32 s26, 0x12000
    s_mov_b32 s27, 0x20000
    v_lshlrev_b32 v116, 7, v64
    s_mul_i32 s50, s37, 54
    s_mul_i32 s51, s36, 14
    s_add_u32 s50, s50, s51
    s_lshl_b32 s50, s50, 7
    s_mul_i32 s51, s37, 18
    s_mul_i32 s53, s36, 5
    s_add_u32 s51, s51, s53
    s_lshl_b32 s51, s51, 7
    s_add_u32 m0, m0, s89
    s_nop 0
    buffer_load_dwordx4 v237, s[16:19], 0 offen nt lds
    s_mov_b32 exec_lo, 0x3fff
    s_mov_b32 exec_hi, 0
    buffer_load_dword v122, v116, s[20:23], s50 offen
    s_mov_b32 exec_lo, 0x1f
    buffer_load_dword v123, v116, s[24:27], s51 offen
    s_mov_b64 exec, -1
    s_add_u32 m0, m0, s89
    s_nop 0
    buffer_load_dwordx4 v238, s[16:19], 0 offen nt lds
    s_cmp_eq_u32 s37, 31
    s_cselect_b32 s39, 1, 0
    s_cmp_eq_u32 s47, 7
    s_cselect_b32 s41, 1, 0
    s_mul_i32 s74, s41, 86016
    s_mul_i32 s81, s36, 2688
    s_add_u32 s81, s81, s40
    s_add_u32 s81, s81, 518400
    s_mul_i32 s82, s39, 19267584
    s_sub_u32 s81, s81, s82
    s_cmp_eq_u32 s36, 3
    s_cselect_b32 s82, s74, 0
    s_sub_u32 s81, s81, s82
    s_mul_i32 s82, s36, 384
    s_add_u32 s82, s82, 93184
    s_add_u32 m0, m0, s89
    s_nop 0
    buffer_load_dwordx4 v239, s[16:19], 0 offen nt lds
    s_mov_b32 s54, -1
    s_mov_b32 s55, 0
    v_lshlrev_b32 v118, 4, v64
    s_add_u32 m0, m0, s89
    s_nop 0
    s_mov_b64 exec, s[54:55]
    buffer_load_dwordx4 v240, s[16:19], 0 offen nt lds
    s_mov_b64 exec, -1
    s_mov_b32 m0, s82
    s_nop 0
    s_mov_b32 exec_lo, 0xffffff
    s_mov_b32 exec_hi, 0
    buffer_load_dwordx4 v118, s[16:19], s81 offen nt lds
    s_mov_b64 exec, -1
    s_mul_i32 s83, s36, 96
    v_add_u32 v48, 0, v64
    v_mul_u32_u24 v48, 43691, v48
    v_lshrrev_b32 v48, 18, v48
    v_lshlrev_b32 v52, 1, v48
    s_movk_i32 s85, -96
    v_lshl_add_u32 v88, v64, 4, s83
    v_lshrrev_b32 v57, 1, v48
    v_bfi_b32 v52, 8, v52, v48
    s_movk_i32 s84, 1152
    v_mad_i32_i24 v88, v48, s85, v88
    v_bfi_b32 v52, 4, v57, v52
    s_mul_i32 s46, s36, 3072
    v_mad_u32_u24 v88, v52, s84, v88
    s_add_u32 m0, s46, 94720
    s_mov_b32 s47, 384
    buffer_load_dwordx4 v88, s[20:23], s47 offen offset:0 lds
    s_mov_b32 s48, 0
    s_mov_b32 s49, 37248
    v_add_u32 v49, 64, v64
    v_mul_u32_u24 v49, 43691, v49
    v_lshrrev_b32 v49, 18, v49
    v_lshlrev_b32 v53, 1, v49
    v_lshl_add_u32 v89, v64, 4, s83
    v_lshrrev_b32 v58, 1, v49
    v_bfi_b32 v53, 8, v53, v49
    v_mad_i32_i24 v89, v49, s85, v89
    v_bfi_b32 v53, 4, v58, v53
    v_mad_u32_u24 v89, v53, s84, v89
    s_mov_b32 s50, 36864
    buffer_load_dwordx4 v89, s[20:23], s47 offen offset:1024 lds
    s_add_u32 s86, s46, 94720
    s_mov_b32 s51, 74112
    v_add_u32 v50, 128, v64
    v_mul_u32_u24 v50, 43691, v50
    v_lshrrev_b32 v50, 18, v50
    v_lshlrev_b32 v56, 1, v50
    v_lshl_add_u32 v90, v64, 4, s83
    v_lshrrev_b32 v59, 1, v50
    v_bfi_b32 v56, 8, v56, v50
    v_mad_i32_i24 v90, v50, s85, v90
    v_bfi_b32 v56, 4, v59, v56
    v_mad_u32_u24 v90, v56, s84, v90
    s_mov_b32 s52, 73728
    buffer_load_dwordx4 v90, s[20:23], s47 offen offset:2048 lds
    s_add_u32 m0, s46, 107008
    s_mov_b32 s53, 110976
    s_mov_b32 s47, 110592
    buffer_load_dwordx4 v88, s[20:23], s48 offen offset:0 lds
    s_mul_i32 s75, s36, 768
    s_add_u32 s75, s75, 90112
    v_and_b32 v65, 15, v64
    v_lshrrev_b32 v66, 4, v64
    v_bfe_u32 v79, v65, 1, 3
    v_mul_u32_u24 v78, 384, v65
    v_xor_b32 v79, v79, v66
    v_lshl_add_u32 v247, v79, 4, v78
    v_lshrrev_b32 v78, 2, v65
    v_mul_u32_u24 v76, 384, v78
    v_lshl_add_u32 v76, v66, 4, v76
    v_add_u32 v242, 0x16c00, v76
    s_add_u32 s87, s75, 336
    buffer_load_dwordx4 v89, s[20:23], s48 offen offset:1024 lds
    s_mul_i32 s44, s36, 13312
    s_add_u32 s44, s44, 36864
    v_and_b32 v76, 1, v66
    v_lshrrev_b32 v77, 1, v66
    v_lshl_add_u32 v76, v76, 2, v78
    v_lshl_add_u32 v76, v77, 4, v76
    v_and_b32 v79, 3, v65
    v_mul_u32_u24 v76, 96, v76
    v_lshl_add_u32 v76, v79, 3, v76
    v_add_u32 v91, s86, v76
    v_add_u32 v243, s45, v76
    v_mul_u32_u24 v71, 37, v65
    v_lshlrev_b32 v70, 2, v64
    v_add_u32 v92, 0, v71
    v_add_u32 v93, 592, v71
    v_add_u32 v94, 1184, v71
    v_lshl_add_u32 v72, v65, 2, s75
    v_add_u32 v70, s75, v70
    v_lshrrev_b32 v92, 8, v92
    v_lshrrev_b32 v93, 8, v93
    v_lshrrev_b32 v94, 8, v94
    v_mov_b32 v95, s87
    v_mad_u32_u24 v92, v92, 24, v72
    v_mad_u32_u24 v93, v93, 24, v72
    v_mad_u32_u24 v94, v94, 24, v72
    v_mul_u32_u24 v83, 148, v66
    v_add_u32 v96, 0, v83
    v_add_u32 v97, 37, v83
    v_add_u32 v98, 74, v83
    v_add_u32 v99, 111, v83
    v_add_u32 v100, 592, v83
    v_add_u32 v101, 629, v83
    v_add_u32 v102, 666, v83
    v_add_u32 v103, 703, v83
    v_lshlrev_b32 v84, 4, v66
    v_lshrrev_b32 v96, 8, v96
    v_lshrrev_b32 v97, 8, v97
    v_lshrrev_b32 v98, 8, v98
    v_lshrrev_b32 v99, 8, v99
    v_lshrrev_b32 v100, 8, v100
    v_lshrrev_b32 v101, 8, v101
    v_lshrrev_b32 v102, 8, v102
    v_lshrrev_b32 v103, 8, v103
    v_mad_u32_u24 v96, v96, 24, v84
    v_mad_u32_u24 v97, v97, 24, v84
    v_mad_u32_u24 v98, v98, 24, v84
    v_mad_u32_u24 v99, v99, 24, v84
    v_mad_u32_u24 v100, v100, 24, v84
    v_mad_u32_u24 v101, v101, 24, v84
    v_mad_u32_u24 v102, v102, 24, v84
    v_mad_u32_u24 v103, v103, 24, v84
    v_sub_u32 v148, v95, v96
    v_sub_u32 v149, v95, v97
    v_sub_u32 v150, v95, v98
    v_sub_u32 v151, v95, v99
    v_sub_u32 v152, v95, v100
    v_sub_u32 v153, v95, v101
    v_sub_u32 v154, v95, v102
    v_sub_u32 v155, v95, v103
    v_add_u32 v104, 1184, v83
    v_add_u32 v105, 1221, v83
    v_add_u32 v106, 1258, v83
    v_add_u32 v107, 1295, v83
    v_lshrrev_b32 v104, 8, v104
    v_lshrrev_b32 v105, 8, v105
    v_lshrrev_b32 v106, 8, v106
    v_lshrrev_b32 v107, 8, v107
    v_mad_u32_u24 v104, v104, 24, v84
    v_mad_u32_u24 v105, v105, 24, v84
    v_mad_u32_u24 v106, v106, 24, v84
    v_mad_u32_u24 v107, v107, 24, v84
    v_add_u32 v250, s44, v118
    s_add_u32 s88, s45, 18432
    s_mov_b32 s42, 2688
    s_mov_b32 s72, 0x11111111
    v_lshlrev_b32 v68, 4, v66
    s_mov_b32 s73, s72
    v_add_u32 v68, 0x26700, v68
    v_cndmask_b32 v242, v68, v242, s[72:73]
    v_lshlrev_b32 v68, 3, v64
    v_mov_b32 v86, 0
    v_mov_b32 v87, 0
    v_add_u32 v68, 0x26700, v68
    ds_write_b64 v68, v[86:87]
    s_mov_b32 s34, 0x1260000
    v_xor_b32 v248, 64, v247
    s_mov_b32 s35, 0x20000
    s_mov_b64 exec, 0
    s_cmp_eq_u32 s36, 1
    s_cbranch_scc1 L_hop1
    s_cmp_eq_u32 s36, 2
    s_cbranch_scc1 L_hop2
    s_cmp_eq_u32 s36, 3
    s_cbranch_scc1 L_hop3
    s_branch L_pad0
L_ret0:
    s_branch L_pad4
L_ret4:
    s_branch L_hopdone
L_hop1:
    s_branch L_pad1
L_ret1:
    s_branch L_pad5
L_ret5:
    s_branch L_hopdone
L_hop2:
    s_branch L_pad2
L_ret2:
    s_branch L_pad6
L_ret6:
    s_branch L_hopdone
L_hop3:
    s_branch L_pad3
L_ret3:
L_hopdone:
    s_mov_b64 exec, -1
    s_waitcnt vmcnt(15)
    v_lshlrev_b32 v80, 16, v80
    v_mul_f32 v80, 0x40ddb3d7, v80
    s_waitcnt vmcnt(13)
    v_lshlrev_b32 v81, 16, v81
    v_lshlrev_b32 v82, 16, v82
    v_mul_f32 v81, 0x40ddb3d7, v81
    v_mul_f32 v82, 0x40ddb3d7, v82
    ds_write_b32 v70, v80 offset:0
    ds_write_b32 v70, v81 offset:256
    ds_write_b32 v70, v82 offset:512
    ds_read_b32 v124, v92 offset:0
    ds_read_b32 v125, v93 offset:64
    ds_read_b32 v126, v94 offset:128
    ds_read_b32 v127, v95 offset:0
    ds_read_b32 v128, v148 offset:336
    ds_read_b32 v129, v149 offset:332
    ds_read_b32 v130, v150 offset:328
    ds_read_b32 v131, v151 offset:324
    ds_read_b32 v132, v152 offset:272
    ds_read_b32 v133, v153 offset:268
    ds_read_b32 v134, v154 offset:264
    ds_read_b32 v135, v155 offset:260
    v_sub_u32 v148, v95, v104
    v_sub_u32 v149, v95, v105
    v_sub_u32 v150, v95, v106
    v_sub_u32 v151, v95, v107
    v_sub_u32 v152, v92, v96
    v_sub_u32 v153, v92, v97
    v_sub_u32 v154, v92, v98
    v_sub_u32 v155, v92, v99
    ds_read_b32 v136, v148 offset:208
    ds_read_b32 v137, v149 offset:204
    ds_read_b32 v138, v150 offset:200
    ds_read_b32 v139, v151 offset:196
    ds_read_b32 v140, v152 offset:336
    ds_read_b32 v141, v153 offset:332
    ds_read_b32 v142, v154 offset:328
    ds_read_b32 v143, v155 offset:324
    v_sub_u32 v148, v92, v100
    v_sub_u32 v149, v92, v101
    v_sub_u32 v150, v92, v102
    v_sub_u32 v151, v92, v103
    v_sub_u32 v152, v92, v104
    v_sub_u32 v153, v92, v105
    v_sub_u32 v154, v92, v106
    v_sub_u32 v155, v92, v107
    ds_read_b32 v144, v148 offset:272
    ds_read_b32 v145, v149 offset:268
    ds_read_b32 v146, v150 offset:264
    ds_read_b32 v147, v151 offset:260
    v_sub_u32 v148, v93, v96
    v_sub_u32 v149, v93, v97
    v_sub_u32 v150, v93, v98
    v_sub_u32 v151, v93, v99
    s_waitcnt lgkmcnt(14)
    ds_write_b128 v250, v[124:127] offset:12288
    ds_read_b32 v124, v152 offset:208
    ds_read_b32 v125, v153 offset:204
    ds_read_b32 v126, v154 offset:200
    ds_read_b32 v127, v155 offset:196
    ds_write_b128 v250, v[128:131] offset:9216
    s_waitcnt lgkmcnt(14)
    ds_write_b128 v250, v[132:135] offset:10240
    ds_write_b128 v250, v[136:139] offset:11264
    v_sub_u32 v152, v93, v100
    v_sub_u32 v153, v93, v101
    v_sub_u32 v154, v93, v102
    v_sub_u32 v155, v93, v103
    ds_read_b32 v132, v152 offset:336
    ds_read_b32 v133, v153 offset:332
    ds_read_b32 v134, v154 offset:328
    ds_read_b32 v135, v155 offset:324
    ds_read_b32 v128, v148 offset:400
    ds_read_b32 v129, v149 offset:396
    ds_read_b32 v130, v150 offset:392
    ds_read_b32 v131, v151 offset:388
    s_waitcnt lgkmcnt(14)
    ds_write_b128 v250, v[140:143] offset:0
    ds_write_b128 v250, v[144:147] offset:1024
    v_sub_u32 v152, v94, v96
    v_sub_u32 v153, v94, v97
    s_waitcnt lgkmcnt(13)
    ds_write_b128 v250, v[124:127] offset:2048
    v_sub_u32 v154, v94, v98
    v_sub_u32 v155, v94, v99
    ds_read_b32 v140, v152 offset:464
    ds_read_b32 v141, v153 offset:460
    ds_read_b32 v142, v154 offset:456
    ds_read_b32 v143, v155 offset:452
    v_sub_u32 v152, v94, v104
    v_sub_u32 v153, v94, v105
    v_sub_u32 v154, v94, v106
    v_sub_u32 v155, v94, v107
    ds_read_b32 v124, v152 offset:336
    ds_read_b32 v125, v153 offset:332
    ds_read_b32 v126, v154 offset:328
    ds_read_b32 v127, v155 offset:324
    v_sub_u32 v148, v93, v104
    v_sub_u32 v149, v93, v105
    v_sub_u32 v150, v93, v106
    v_sub_u32 v151, v93, v107
    ds_read_b32 v136, v148 offset:272
    ds_read_b32 v137, v149 offset:268
    ds_read_b32 v138, v150 offset:264
    ds_read_b32 v139, v151 offset:260
    v_sub_u32 v148, v94, v100
    v_sub_u32 v149, v94, v101
    v_sub_u32 v150, v94, v102
    v_sub_u32 v151, v94, v103
    ds_read_b32 v144, v148 offset:400
    ds_read_b32 v145, v149 offset:396
    ds_read_b32 v146, v150 offset:392
    ds_read_b32 v147, v151 offset:388
    s_waitcnt lgkmcnt(14)
    ds_write_b128 v250, v[132:135] offset:4096
    ds_write_b128 v250, v[128:131] offset:3072
    s_waitcnt lgkmcnt(14)
    ds_write_b128 v250, v[140:143] offset:6144
    s_waitcnt lgkmcnt(11)
    ds_write_b128 v250, v[124:127] offset:8192
    s_waitcnt lgkmcnt(8)
    ds_write_b128 v250, v[136:139] offset:5120
    s_waitcnt lgkmcnt(5)
    ds_write_b128 v250, v[144:147] offset:7168
    buffer_load_dwordx4 v90, s[20:23], s48 offen offset:2048 lds
    s_add_u32 m0, s46, 119296
    s_mov_b32 s48, 147840
    buffer_load_dwordx4 v88, s[20:23], s49 offen offset:0 lds
    buffer_load_dwordx4 v89, s[20:23], s49 offen offset:1024 lds
    buffer_load_dwordx4 v90, s[20:23], s49 offen offset:2048 lds
    s_add_u32 m0, s46, 131584
    s_mov_b32 s49, 147456
    buffer_load_dwordx4 v88, s[20:23], s50 offen offset:0 lds
    s_waitcnt vmcnt(7)
    s_barrier
    s_branch L_main
.p2align 12
L_main:
L_pad0:
    s_cbranch_execz L_ret0
    s_add_u32 s84, s46, 94720
    ds_read_b128 v[212:215], v242 offset:0
    ds_read_b128 v[216:219], v247 offset:0
    ds_read_b128 v[220:223], v247 offset:6144
    ds_read_b128 v[224:227], v247 offset:12288
    buffer_load_dwordx4 v89, s[20:23], s50 offen offset:1024 lds
    s_lshl_b32 s83, s36, 5
    s_lshl_b32 s82, s36, 6
    s_add_u32 s83, s83, 192
    ds_read_b64_tr_b16 a[0:1], v91 offset:0
    ds_read_b64_tr_b16 a[2:3], v91 offset:768
    ds_read_b64_tr_b16 a[24:25], v91 offset:32
    ds_read_b64_tr_b16 a[26:27], v91 offset:800
    ds_read_b64_tr_b16 a[48:49], v91 offset:64
    ds_read_b64_tr_b16 a[50:51], v91 offset:832
    v_lshlrev_b32 v78, 4, v64
    v_add_u32 v249, 0x17200, v78
    s_lshr_b32 s79, s36, 1
    s_and_b32 s80, s36, 1
    buffer_load_dwordx4 v90, s[20:23], s50 offen offset:2048 lds
    s_add_u32 m0, s46, 143872
    s_mov_b32 s50, 184704
    v_lshrrev_b32 v78, 2, v65
    v_lshl_add_u32 v76, v66, 2, v78
    v_mul_u32_u24 v76, 96, v76
    v_and_b32 v79, 3, v65
    v_mad_i32_i24 v75, v48, -6, v64
    v_add_u32 v76, s84, v76
    v_cmp_gt_i32 vcc, 4, v75
    v_lshl_add_u32 v241, v79, 4, v76
    v_lshlrev_b32 v73, 4, v64
    v_lshl_add_u32 v76, v79, 3, v76
    s_lshl_b32 s78, s36, 10
    s_lshl_b32 s79, s79, 10
    buffer_load_dwordx4 v88, s[20:23], s51 offen offset:0 lds
    s_lshl_b32 s80, s80, 3
    s_add_u32 s79, s79, s80
    s_add_u32 s79, s79, 4096
    v_add_u32 v78, s82, v73
    v_add_u32 v79, s83, v73
    v_mad_i32_i24 v75, v49, -6, v64
    v_cndmask_b32 v244, v79, v78, vcc
    v_cmp_gt_i32 vcc, -60, v75
    v_mad_i32_i24 v75, v50, -6, v64
    v_add_u32 v251, s78, v249
    v_cndmask_b32 v245, v79, v78, vcc
    v_cmp_gt_i32 vcc, -124, v75
    s_movk_i32 s78, 288
    s_waitcnt lgkmcnt(4)
    v_mfma_f32_16x16x32_bf16 v[172:175], a[0:3], v[212:215], 0
    s_mov_b32 s85, -7
    buffer_load_dwordx4 v89, s[20:23], s51 offen offset:1024 lds
    s_mov_b32 s81, 0xf000
    s_mov_b32 s80, 0xe1c01e3
    v_mfma_f32_16x16x32_bf16 v[196:199], a[0:3], v[216:219], 0
    s_mov_b32 s82, 0x0
    v_cndmask_b32 v246, v79, v78, vcc
    s_waitcnt lgkmcnt(2)
    v_mfma_f32_16x16x32_bf16 v[176:179], a[24:27], v[212:215], 0
    s_mov_b32 s83, 0xc3873c78
    s_waitcnt lgkmcnt(0)
    v_mfma_f32_16x16x32_bf16 v[180:183], a[48:51], v[212:215], 0
    s_mov_b32 s84, 0x0
    v_add_u32 v252, s79, v249
    v_mad_u32_u24 v244, v48, s78, v244
    v_mfma_f32_16x16x32_bf16 v[200:203], a[24:27], v[216:219], 0
    s_mov_b32 s79, 0x0
    buffer_load_dwordx4 v90, s[20:23], s51 offen offset:2048 lds
    s_add_u32 m0, s45, 18432
    s_mov_b32 s51, 184320
    v_mfma_f32_16x16x32_bf16 v[204:207], a[48:51], v[216:219], 0
    s_mov_b32 s56, 0xffff
    v_mad_u32_u24 v245, v49, s78, v245
    v_mfma_f32_16x16x32_bf16 v[164:167], a[0:3], v[220:223], 0
    s_mov_b32 s57, 0
    v_mad_u32_u24 v246, v50, s78, v246
    v_mov_b32 v73, 0x3ef441d2
    v_mfma_f32_16x16x32_bf16 v[168:171], a[24:27], v[220:223], 0
    s_mov_b32 s78, 0x3870c78f
    buffer_load_dwordx4 v88, s[20:23], s52 offen offset:0 lds
    s_mov_b32 s4, 0xffffffff
    s_mov_b32 s5, 0x0
    v_mfma_f32_16x16x32_bf16 v[124:127], a[48:51], v[220:223], 0
    v_cndmask_b32 v6, 0, v73, s[78:79]
    v_mad_i32_i24 v32, v40, s85, v32
    v_mfma_f32_16x16x32_bf16 v[140:143], a[0:3], v[224:227], 0
    s_mov_b32 s78, 0xffffffff
    v_mad_i32_i24 v33, v41, s85, v33
    v_mfma_f32_16x16x32_bf16 v[144:147], a[24:27], v[224:227], 0
    s_mov_b32 s79, 0x0
    v_mad_i32_i24 v34, v42, s85, v34
    v_mad_i32_i24 v35, v43, s85, v35
    v_mfma_f32_16x16x32_bf16 v[148:151], a[48:51], v[224:227], 0
    s_cmp_lg_u32 s39, 0
    s_cselect_b64 s[78:79], s[78:79], 0
    v_mad_i32_i24 v36, v44, s85, v36
    v_cndmask_b32 v14, 0, v73, s[80:81]
    v_cndmask_b32 v22, 0, v73, s[82:83]
    v_mov_b32 v75, 0x3f8041d3
    s_mov_b32 s85, 0xffff0000
    s_mov_b32 s82, 0x0
    s_mov_b32 s8, 0x0
    s_mov_b32 s76, 0
    s_mov_b32 s77, 0
    s_lshl_b64 s[58:59], s[56:57], 16
    s_lshl_b64 s[60:61], s[56:57], 32
    s_lshl_b64 s[62:63], s[56:57], 48
    s_waitcnt vmcnt(10)
    ds_read_b64_tr_b16 a[72:73], v91 offset:12288
    ds_read_b64_tr_b16 a[74:75], v91 offset:13056
    ds_read_b64_tr_b16 a[96:97], v91 offset:12320
    ds_read_b64_tr_b16 a[98:99], v91 offset:13088
    ds_read_b64_tr_b16 a[120:121], v91 offset:12352
    ds_read_b64_tr_b16 a[122:123], v91 offset:13120
    buffer_load_dwordx4 v89, s[20:23], s52 offen offset:1024 lds
    s_mov_b32 s80, 0xfff0fff
    s_mov_b32 s81, 0xf000f000
    buffer_load_dwordx4 v90, s[20:23], s52 offen offset:2048 lds
    s_add_u32 m0, s46, 94720
    s_mov_b32 s52, 768
    s_mov_b32 s83, 0xffffffff
    v_cndmask_b32 v38, 0, v75, s[78:79]
    v_cndmask_b32 v30, 0, v73, s[84:85]
    s_cmp_lg_u32 s39, 0
    s_cselect_b64 s[80:81], s[80:81], 0
    s_cmp_lg_u32 s39, 0
    s_cselect_b64 s[82:83], s[82:83], 0
    s_mov_b32 s78, 0xf000f000
    s_mov_b32 s79, 0xf000f000
    buffer_load_dwordx4 v88, s[20:23], s53 offen offset:0 lds
    s_waitcnt lgkmcnt(4)
    v_mfma_f32_16x16x32_bf16 v[184:187], a[72:75], v[212:215], 0
    s_cmp_lg_u32 s39, 0
    s_cselect_b64 s[84:85], s[56:57], 0
    v_mfma_f32_16x16x32_bf16 v[208:211], a[72:75], v[216:219], 0
    s_waitcnt lgkmcnt(2)
    v_cndmask_b32 v46, 0, v75, s[80:81]
    v_cndmask_b32 v54, 0, v75, s[82:83]
    v_mfma_f32_16x16x32_bf16 v[188:191], a[96:99], v[212:215], 0
    s_cmp_lg_u32 s41, 0
    s_cselect_b64 s[78:79], s[78:79], 0
    v_mfma_f32_16x16x32_bf16 v[156:159], a[96:99], v[216:219], 0
    s_mov_b32 s80, 0x0
    s_waitcnt vmcnt(10) lgkmcnt(0)
    ds_read_b64_tr_b16 a[4:5], v91 offset:24576
    buffer_load_dwordx4 v89, s[20:23], s53 offen offset:1024 lds
    s_mov_b32 s81, 0xffffffff
    s_mov_b32 s82, 0xffff0000
    v_mfma_f32_16x16x32_bf16 v[192:195], a[120:123], v[212:215], 0
    s_mov_b32 s83, 0xffff0000
    ds_read_b128 v[212:215], v242 offset:64
    v_mfma_f32_16x16x32_bf16 v[160:163], a[120:123], v[216:219], 0
    s_andn2_b64 s[86:87], s[78:79], s[82:83]
    ds_read_b128 v[216:219], v248 offset:0
    ds_read_b64_tr_b16 a[6:7], v91 offset:25344
    v_mfma_f32_16x16x32_bf16 v[128:131], a[72:75], v[220:223], 0
    ds_read_b64_tr_b16 a[28:29], v91 offset:24608
    ds_read_b64_tr_b16 a[30:31], v91 offset:25376
    buffer_load_dwordx4 v90, s[20:23], s53 offen offset:2048 lds
    s_add_u32 m0, s46, 107008
    s_mov_b32 s53, 37632
    v_mfma_f32_16x16x32_bf16 v[132:135], a[96:99], v[220:223], 0
    ds_read_b64_tr_b16 a[52:53], v91 offset:24640
    ds_read_b64_tr_b16 a[54:55], v91 offset:25408
    v_mfma_f32_16x16x32_bf16 v[136:139], a[120:123], v[220:223], 0
    ds_read_b128 v[220:223], v248 offset:6144
    v_cndmask_b32 v39, 0, v75, s[84:85]
    v_mfma_f32_16x16x32_bf16 v[152:155], a[72:75], v[224:227], 0
    v_cndmask_b32 v47, 0, v75, s[84:85]
    v_cndmask_b32 v55, 0, v75, s[84:85]
    v_mfma_f32_16x16x32_bf16 v[228:231], a[96:99], v[224:227], 0
    buffer_load_dwordx4 v88, s[20:23], s47 offen offset:0 lds
    v_mfma_f32_16x16x32_bf16 v[232:235], a[120:123], v[224:227], 0
    s_cmp_lg_u32 s39, 0
    s_cselect_b64 s[80:81], s[80:81], -1
    s_cselect_b64 s[84:85], -1, s[78:79]
    ds_read_b128 v[224:227], v248 offset:12288
    s_andn2_b64 s[80:81], s[80:81], s[86:87]
    v_add_u32 v32, 4, v32
    v_mov_b32 v253, 0
    s_waitcnt lgkmcnt(6)
    v_mfma_f32_16x16x32_bf16 v[172:175], a[4:7], v[212:215], v[172:175]
    s_mov_b32 s86, 0x3870c78f
    s_and_b64 s[80:81], s[80:81], s[84:85]
    buffer_load_dwordx4 v89, s[20:23], s47 offen offset:1024 lds
    s_mov_b32 s87, 0x3870c78f
    s_waitcnt vmcnt(11) lgkmcnt(4)
    v_mfma_f32_16x16x32_bf16 v[176:179], a[28:31], v[212:215], v[176:179]
    ds_read_b64_tr_b16 a[76:77], v91 offset:36864
    s_waitcnt lgkmcnt(3)
    v_mfma_f32_16x16x32_bf16 v[180:183], a[52:55], v[212:215], v[180:183]
    ds_read_b64_tr_b16 a[78:79], v91 offset:37632
    ds_read_b64_tr_b16 a[100:101], v91 offset:36896
    v_mfma_f32_16x16x32_bf16 v[196:199], a[4:7], v[216:219], v[196:199]
    ds_read_b64_tr_b16 a[102:103], v91 offset:37664
    ds_read_b64_tr_b16 a[124:125], v91 offset:36928
    v_mfma_f32_16x16x32_bf16 v[200:203], a[28:31], v[216:219], v[200:203]
    ds_read_b64_tr_b16 a[126:127], v91 offset:37696
    buffer_load_dwordx4 v90, s[20:23], s47 offen offset:2048 lds
    s_add_u32 m0, s46, 119296
    s_mov_b32 s47, 74496
    v_mfma_f32_16x16x32_bf16 v[204:207], a[52:55], v[216:219], v[204:207]
    s_cmp_lg_u32 s39, 0
    s_cselect_b64 s[4:5], s[4:5], -1
    s_waitcnt lgkmcnt(7)
    v_mfma_f32_16x16x32_bf16 v[164:167], a[4:7], v[220:223], v[164:167]
    s_cmp_lg_u32 s41, 0
    s_cselect_b64 s[86:87], s[86:87], -1
    v_mfma_f32_16x16x32_bf16 v[168:171], a[28:31], v[220:223], v[168:171]
    s_and_b64 s[4:5], s[4:5], s[86:87]
    s_or_b32 s86, s39, s41
    s_and_b64 s[84:85], s[84:85], s[56:57]
    buffer_load_dwordx4 v88, s[20:23], s48 offen offset:0 lds
    v_mfma_f32_16x16x32_bf16 v[124:127], a[52:55], v[220:223], v[124:127]
    s_waitcnt lgkmcnt(4)
    s_cmp_lg_u32 s86, 0
    s_cselect_b64 s[4:5], s[4:5], 0
    v_mfma_f32_16x16x32_bf16 v[184:187], a[76:79], v[212:215], v[184:187]
    s_mov_b32 s6, 0xfff0fff
    s_waitcnt lgkmcnt(2)
    v_mfma_f32_16x16x32_bf16 v[188:191], a[100:103], v[212:215], v[188:191]
    s_mov_b32 s7, 0xf000f000
    v_add_u32 v33, 4, v33
    v_mfma_f32_16x16x32_bf16 v[208:211], a[76:79], v[216:219], v[208:211]
    s_mov_b32 s87, 0xe1cf1e3
    s_waitcnt lgkmcnt(0)
    buffer_load_dwordx4 v89, s[20:23], s48 offen offset:1024 lds
    s_mov_b32 s86, 0xe1cf1e3
    s_waitcnt vmcnt(11)
    v_mfma_f32_16x16x32_bf16 v[192:195], a[124:127], v[212:215], v[192:195]
    ds_read_b128 v[212:215], v242 offset:128
    ds_read_b64_tr_b16 a[8:9], v91 offset:49152
    v_mfma_f32_16x16x32_bf16 v[156:159], a[100:103], v[216:219], v[156:159]
    ds_read_b64_tr_b16 a[10:11], v91 offset:49920
    ds_read_b64_tr_b16 a[32:33], v91 offset:49184
    v_mfma_f32_16x16x32_bf16 v[160:163], a[124:127], v[216:219], v[160:163]
    ds_read_b128 v[216:219], v247 offset:128
    ds_read_b64_tr_b16 a[34:35], v91 offset:49952
    v_mfma_f32_16x16x32_bf16 v[128:131], a[76:79], v[220:223], v[128:131]
    ds_read_b64_tr_b16 a[56:57], v91 offset:49216
    ds_read_b64_tr_b16 a[58:59], v91 offset:49984
    buffer_load_dwordx4 v90, s[20:23], s48 offen offset:2048 lds
    s_add_u32 m0, s46, 131584
    s_mov_b32 s48, 111360
    v_mfma_f32_16x16x32_bf16 v[132:135], a[100:103], v[220:223], v[132:135]
    s_cmp_lg_u32 s39, 0
    s_cselect_b64 s[6:7], s[6:7], -1
    v_mfma_f32_16x16x32_bf16 v[136:139], a[124:127], v[220:223], v[136:139]
    ds_read_b128 v[220:223], v247 offset:6272
    v_lshrrev_b32 v32, 3, v32
    v_mfma_f32_16x16x32_bf16 v[140:143], a[4:7], v[224:227], v[140:143]
    buffer_load_dwordx4 v88, s[20:23], s49 offen offset:0 lds
    v_mfma_f32_16x16x32_bf16 v[144:147], a[28:31], v[224:227], v[144:147]
    s_cmp_lg_u32 s41, 0
    s_cselect_b64 s[86:87], s[86:87], -1
    v_mfma_f32_16x16x32_bf16 v[148:151], a[52:55], v[224:227], v[148:151]
    s_and_b64 s[6:7], s[6:7], s[86:87]
    s_or_b32 s86, s39, s41
    v_add_u32 v34, 4, v34
    v_mfma_f32_16x16x32_bf16 v[152:155], a[76:79], v[224:227], v[152:155]
    s_waitcnt lgkmcnt(6)
    s_cmp_lg_u32 s86, 0
    s_cselect_b64 s[6:7], s[6:7], 0
    v_mfma_f32_16x16x32_bf16 v[228:231], a[100:103], v[224:227], v[228:231]
    s_mov_b32 s9, 0xffffffff
    buffer_load_dwordx4 v89, s[20:23], s49 offen offset:1024 lds
    s_mov_b32 s87, 0xc3873c78
    s_mov_b32 s86, 0xc3873c78
    v_mfma_f32_16x16x32_bf16 v[232:235], a[124:127], v[224:227], v[232:235]
    s_waitcnt vmcnt(11) lgkmcnt(1)
    ds_read_b128 v[224:227], v247 offset:12416
    ds_read_b64_tr_b16 a[80:81], v243 offset:18432
    v_mfma_f32_16x16x32_bf16 v[172:175], a[8:11], v[212:215], v[172:175]
    ds_read_b64_tr_b16 a[82:83], v243 offset:19200
    ds_read_b64_tr_b16 a[104:105], v243 offset:18464
    v_mfma_f32_16x16x32_bf16 v[176:179], a[32:35], v[212:215], v[176:179]
    ds_read_b64_tr_b16 a[106:107], v243 offset:19232
    ds_read_b64_tr_b16 a[128:129], v243 offset:18496
    v_mfma_f32_16x16x32_bf16 v[180:183], a[56:59], v[212:215], v[180:183]
    ds_read_b64_tr_b16 a[130:131], v243 offset:19264
    buffer_load_dwordx4 v90, s[20:23], s49 offen offset:2048 lds
    s_add_u32 m0, s46, 143872
    s_mov_b32 s49, 148224
    v_mfma_f32_16x16x32_bf16 v[196:199], a[8:11], v[216:219], v[196:199]
    s_cmp_lg_u32 s39, 0
    s_cselect_b64 s[8:9], s[8:9], -1
    v_mfma_f32_16x16x32_bf16 v[200:203], a[32:35], v[216:219], v[200:203]
    s_cmp_lg_u32 s41, 0
    s_cselect_b64 s[86:87], s[86:87], -1
    v_mfma_f32_16x16x32_bf16 v[204:207], a[56:59], v[216:219], v[204:207]
    s_and_b64 s[8:9], s[8:9], s[86:87]
    v_lshrrev_b32 v33, 3, v33
    s_waitcnt lgkmcnt(7)
    v_mfma_f32_16x16x32_bf16 v[164:167], a[8:11], v[220:223], v[164:167]
    s_or_b32 s86, s39, s41
    buffer_load_dwordx4 v88, s[20:23], s50 offen offset:0 lds
    s_mov_b32 s64, 0x000f000f
    v_mfma_f32_16x16x32_bf16 v[168:171], a[32:35], v[220:223], v[168:171]
    s_waitcnt lgkmcnt(4)
    v_lshl_or_b32 v253, v32, 0, v253
    v_mfma_f32_16x16x32_bf16 v[184:187], a[80:83], v[212:215], v[184:187]
    v_add_u32 v35, 4, v35
    v_lshrrev_b32 v34, 3, v34
    v_mfma_f32_16x16x32_bf16 v[208:211], a[80:83], v[216:219], v[208:211]
    s_waitcnt lgkmcnt(2)
    v_lshl_or_b32 v253, v33, 1, v253
    v_add_u32 v36, 4, v36
    v_mfma_f32_16x16x32_bf16 v[188:191], a[104:107], v[212:215], v[188:191]
    s_waitcnt vmcnt(10) lgkmcnt(0)
    ds_read_b64_tr_b16 a[12:13], v91 offset:0
    buffer_load_dwordx4 v89, s[20:23], s50 offen offset:1024 lds
    v_mfma_f32_16x16x32_bf16 v[192:195], a[128:131], v[212:215], v[192:195]
    ds_read_b128 v[212:215], v242 offset:192
    ds_read_b64_tr_b16 a[14:15], v91 offset:768
    v_mfma_f32_16x16x32_bf16 v[156:159], a[104:107], v[216:219], v[156:159]
    ds_read_b64_tr_b16 a[36:37], v91 offset:32
    ds_read_b64_tr_b16 a[38:39], v91 offset:800
    v_mfma_f32_16x16x32_bf16 v[160:163], a[128:131], v[216:219], v[160:163]
    ds_read_b128 v[216:219], v248 offset:128
    ds_read_b64_tr_b16 a[60:61], v91 offset:64
    buffer_load_dwordx4 v90, s[20:23], s50 offen offset:2048 lds
    s_add_u32 m0, s45, 18432
    s_mov_b32 s50, 185088
    v_mfma_f32_16x16x32_bf16 v[124:127], a[56:59], v[220:223], v[124:127]
    ds_read_b64_tr_b16 a[62:63], v91 offset:832
    v_lshrrev_b32 v35, 3, v35
    v_mfma_f32_16x16x32_bf16 v[128:131], a[80:83], v[220:223], v[128:131]
    s_cmp_lg_u32 s86, 0
    s_cselect_b64 s[8:9], s[8:9], 0
    v_mfma_f32_16x16x32_bf16 v[132:135], a[104:107], v[220:223], v[132:135]
    s_mov_b32 s65, s64
    v_lshl_or_b32 v253, v34, 2, v253
    v_mov_b32 v74, 0xbef4c1d2
    v_mfma_f32_16x16x32_bf16 v[136:139], a[128:131], v[220:223], v[136:139]
    s_or_b32 s86, s39, s41
    ds_read_b128 v[220:223], v248 offset:6272
    buffer_load_dwordx4 v88, s[20:23], s51 offen offset:0 lds
    s_mov_b32 s38, 0x3e553b95
    s_mov_b32 s43, 5376
    v_mfma_f32_16x16x32_bf16 v[140:143], a[8:11], v[224:227], v[140:143]
    s_lshl_b64 s[66:67], s[64:65], 4
    v_lshrrev_b32 v36, 3, v36
    v_lshl_or_b32 v253, v35, 3, v253
    v_mfma_f32_16x16x32_bf16 v[144:147], a[32:35], v[224:227], v[144:147]
    s_lshl_b64 s[68:69], s[64:65], 8
    v_mov_b32 v254, 0xfe800000
    v_add_u32 v255, 64, v76
    v_mfma_f32_16x16x32_bf16 v[148:151], a[56:59], v[224:227], v[148:151]
    s_lshl_b64 s[70:71], s[64:65], 12
    s_movk_i32 s79, 384
    buffer_load_dwordx4 v89, s[20:23], s51 offen offset:1024 lds
    s_waitcnt vmcnt(11)
    v_mfma_f32_16x16x32_bf16 v[152:155], a[80:83], v[224:227], v[152:155]
    s_waitcnt lgkmcnt(6)
    ds_read_b64_tr_b16 a[84:85], v91 offset:12288
    ds_read_b64_tr_b16 a[86:87], v91 offset:13056
    v_mfma_f32_16x16x32_bf16 v[228:231], a[104:107], v[224:227], v[228:231]
    s_waitcnt lgkmcnt(6)
    ds_read_b64_tr_b16 a[108:109], v91 offset:12320
    ds_read_b64_tr_b16 a[110:111], v91 offset:13088
    v_mfma_f32_16x16x32_bf16 v[232:235], a[128:131], v[224:227], v[232:235]
    s_waitcnt lgkmcnt(5)
    ds_read_b128 v[224:227], v248 offset:12416
    ds_read_b64_tr_b16 a[132:133], v91 offset:12352
    v_mfma_f32_16x16x32_bf16 v[172:175], a[12:15], v[212:215], v[172:175]
    ds_read_b64_tr_b16 a[134:135], v91 offset:13120
    buffer_load_dwordx4 v90, s[20:23], s51 offen offset:2048 lds
    s_add_u32 m0, s46, 94720
    v_mfma_f32_16x16x32_bf16 v[176:179], a[36:39], v[212:215], v[176:179]
    v_cndmask_b32 v62, 0, v75, s[80:81]
    v_cndmask_b32 v63, 0, v75, s[84:85]
    v_mfma_f32_16x16x32_bf16 v[180:183], a[60:63], v[212:215], v[180:183]
    v_cndmask_b32 v7, 0, v74, s[56:57]
    v_cndmask_b32 v15, 0, v74, s[56:57]
    v_mfma_f32_16x16x32_bf16 v[196:199], a[12:15], v[216:219], v[196:199]
    v_cndmask_b32 v23, 0, v74, s[56:57]
    v_cndmask_b32 v31, 0, v74, s[56:57]
    v_mfma_f32_16x16x32_bf16 v[200:203], a[36:39], v[216:219], v[200:203]
    buffer_load_dwordx4 v88, s[20:23], s52 offen offset:0 lds
    s_waitcnt lgkmcnt(5)
    v_mfma_f32_16x16x32_bf16 v[184:187], a[84:87], v[212:215], v[184:187]
    s_cmp_lg_u32 s86, 0
    s_cselect_b64 s[10:11], s[56:57], 0
    v_mfma_f32_16x16x32_bf16 v[204:207], a[60:63], v[216:219], v[204:207]
    s_mov_b32 s51, 0
    v_lshl_or_b32 v253, v36, 4, v253
    s_waitcnt lgkmcnt(3)
    v_mfma_f32_16x16x32_bf16 v[188:191], a[108:111], v[212:215], v[188:191]
    s_mov_b32 s80, 83328
    s_lshl_b32 s78, s36, 1
    v_mfma_f32_16x16x32_bf16 v[208:211], a[84:87], v[216:219], v[208:211]
    s_mul_i32 s81, s36, 12
    s_movk_i32 s85, -7
    buffer_load_dwordx4 v89, s[20:23], s52 offen offset:1024 lds
    s_lshl_b32 s82, s36, 6
    s_lshl_b32 s83, s36, 5
    s_add_u32 s83, s83, 256
    v_mfma_f32_16x16x32_bf16 v[156:159], a[108:111], v[216:219], v[156:159]
    s_mov_b32 s84, 0xc387c387
    s_waitcnt lgkmcnt(0)
    v_mfma_f32_16x16x32_bf16 v[192:195], a[132:135], v[212:215], v[192:195]
    s_lshl_b32 s83, s36, 5
    ds_read_b128 v[212:215], v242 offset:256
    s_waitcnt vmcnt(11)
    v_mfma_f32_16x16x32_bf16 v[160:163], a[132:135], v[216:219], v[160:163]
    s_add_u32 s83, s83, 256
    ds_read_b128 v[216:219], v247 offset:256
    buffer_load_dwordx4 v90, s[20:23], s52 offen offset:2048 lds
    s_add_u32 m0, s46, 107008
    s_mov_b32 s52, 12288
    v_mfma_f32_16x16x32_bf16 v[164:167], a[12:15], v[220:223], v[164:167]
    ds_read_b64_tr_b16 a[16:17], v91 offset:24576
    ds_read_b64_tr_b16 a[18:19], v91 offset:25344
    v_mfma_f32_16x16x32_bf16 v[168:171], a[36:39], v[220:223], v[168:171]
    ds_read_b64_tr_b16 a[40:41], v91 offset:24608
    ds_read_b64_tr_b16 a[42:43], v91 offset:25376
    v_mfma_f32_16x16x32_bf16 v[124:127], a[60:63], v[220:223], v[124:127]
    ds_read_b64_tr_b16 a[64:65], v91 offset:24640
    ds_read_b64_tr_b16 a[66:67], v91 offset:25408
    v_mfma_f32_16x16x32_bf16 v[128:131], a[84:87], v[220:223], v[128:131]
    buffer_load_dwordx4 v88, s[20:23], s53 offen offset:0 lds
    v_mfma_f32_16x16x32_bf16 v[132:135], a[108:111], v[220:223], v[132:135]
    v_mfma_f32_16x16x32_bf16 v[136:139], a[132:135], v[220:223], v[136:139]
    ds_read_b128 v[220:223], v247 offset:6400
    v_mfma_f32_16x16x32_bf16 v[140:143], a[12:15], v[224:227], v[140:143]
    v_mfma_f32_16x16x32_bf16 v[144:147], a[36:39], v[224:227], v[144:147]
    s_waitcnt vmcnt(10)
    ds_read_b64_tr_b16 a[88:89], v91 offset:36864
    buffer_load_dwordx4 v89, s[20:23], s53 offen offset:1024 lds
    v_mfma_f32_16x16x32_bf16 v[148:151], a[60:63], v[224:227], v[148:151]
    ds_read_b64_tr_b16 a[90:91], v91 offset:37632
    ds_read_b64_tr_b16 a[112:113], v91 offset:36896
    v_mfma_f32_16x16x32_bf16 v[152:155], a[84:87], v[224:227], v[152:155]
    s_waitcnt lgkmcnt(8)
    ds_read_b64_tr_b16 a[114:115], v91 offset:37664
    ds_read_b64_tr_b16 a[136:137], v91 offset:36928
    v_mfma_f32_16x16x32_bf16 v[228:231], a[108:111], v[224:227], v[228:231]
    s_waitcnt lgkmcnt(8)
    ds_read_b64_tr_b16 a[138:139], v91 offset:37696
    v_mfma_f32_16x16x32_bf16 v[232:235], a[132:135], v[224:227], v[232:235]
    s_waitcnt lgkmcnt(7)
    ds_read_b128 v[224:227], v247 offset:12544
    buffer_load_dwordx4 v90, s[20:23], s53 offen offset:2048 lds
    s_add_u32 m0, s46, 119296
    s_mov_b32 s53, 24576
    v_mfma_f32_16x16x32_bf16 v[172:175], a[16:19], v[212:215], v[172:175]
    v_mfma_f32_16x16x32_bf16 v[176:179], a[40:43], v[212:215], v[176:179]
    v_mfma_f32_16x16x32_bf16 v[180:183], a[64:67], v[212:215], v[180:183]
    buffer_load_dwordx4 v88, s[20:23], s47 offen offset:0 lds
    s_waitcnt lgkmcnt(5)
    v_mfma_f32_16x16x32_bf16 v[184:187], a[88:91], v[212:215], v[184:187]
    v_mfma_f32_16x16x32_bf16 v[196:199], a[16:19], v[216:219], v[196:199]
    s_waitcnt lgkmcnt(3)
    v_mfma_f32_16x16x32_bf16 v[188:191], a[112:115], v[212:215], v[188:191]
    s_waitcnt lgkmcnt(1)
    v_mfma_f32_16x16x32_bf16 v[192:195], a[136:139], v[212:215], v[192:195]
    ds_read_b128 v[212:215], v242 offset:320
    buffer_load_dwordx4 v89, s[20:23], s47 offen offset:1024 lds
    s_waitcnt vmcnt(11)
    v_mfma_f32_16x16x32_bf16 v[200:203], a[40:43], v[216:219], v[200:203]
    ds_read_b64_tr_b16 a[20:21], v91 offset:49152
    ds_read_b64_tr_b16 a[22:23], v91 offset:49920
    v_mfma_f32_16x16x32_bf16 v[204:207], a[64:67], v[216:219], v[204:207]
    ds_read_b64_tr_b16 a[44:45], v91 offset:49184
    ds_read_b64_tr_b16 a[46:47], v91 offset:49952
    v_mfma_f32_16x16x32_bf16 v[208:211], a[88:91], v[216:219], v[208:211]
    ds_read_b64_tr_b16 a[68:69], v91 offset:49216
    ds_read_b64_tr_b16 a[70:71], v91 offset:49984
    v_mfma_f32_16x16x32_bf16 v[156:159], a[112:115], v[216:219], v[156:159]
    buffer_load_dwordx4 v90, s[20:23], s47 offen offset:2048 lds
    s_add_u32 m0, s46, 131584
    s_mov_b32 s47, 36864
    v_mfma_f32_16x16x32_bf16 v[160:163], a[136:139], v[216:219], v[160:163]
    ds_read_b128 v[216:219], v248 offset:256
    v_mfma_f32_16x16x32_bf16 v[164:167], a[16:19], v[220:223], v[164:167]
    v_mfma_f32_16x16x32_bf16 v[168:171], a[40:43], v[220:223], v[168:171]
    v_mfma_f32_16x16x32_bf16 v[124:127], a[64:67], v[220:223], v[124:127]
    buffer_load_dwordx4 v88, s[20:23], s48 offen offset:0 lds
    v_mfma_f32_16x16x32_bf16 v[128:131], a[88:91], v[220:223], v[128:131]
    s_waitcnt lgkmcnt(8)
    v_mfma_f32_16x16x32_bf16 v[132:135], a[112:115], v[220:223], v[132:135]
    v_mfma_f32_16x16x32_bf16 v[136:139], a[136:139], v[220:223], v[136:139]
    ds_read_b128 v[220:223], v248 offset:6400
    v_mfma_f32_16x16x32_bf16 v[140:143], a[16:19], v[224:227], v[140:143]
    s_waitcnt vmcnt(10)
    ds_read_b64_tr_b16 a[92:93], v243 offset:18432
    buffer_load_dwordx4 v89, s[20:23], s48 offen offset:1024 lds
    v_mfma_f32_16x16x32_bf16 v[144:147], a[40:43], v[224:227], v[144:147]
    ds_read_b64_tr_b16 a[94:95], v243 offset:19200
    ds_read_b64_tr_b16 a[116:117], v243 offset:18464
    v_mfma_f32_16x16x32_bf16 v[148:151], a[64:67], v[224:227], v[148:151]
    ds_read_b64_tr_b16 a[118:119], v243 offset:19232
    ds_read_b64_tr_b16 a[140:141], v243 offset:18496
    v_mfma_f32_16x16x32_bf16 v[152:155], a[88:91], v[224:227], v[152:155]
    s_waitcnt lgkmcnt(11)
    ds_read_b64_tr_b16 a[142:143], v243 offset:19264
    v_mfma_f32_16x16x32_bf16 v[228:231], a[112:115], v[224:227], v[228:231]
    s_waitcnt lgkmcnt(10)
    buffer_load_dwordx4 v90, s[20:23], s48 offen offset:2048 lds
    s_add_u32 m0, s46, 143872
    s_mov_b32 s48, 49152
    v_mfma_f32_16x16x32_bf16 v[232:235], a[136:139], v[224:227], v[232:235]
    s_waitcnt lgkmcnt(8)
    ds_read_b128 v[224:227], v248 offset:12544
    v_mfma_f32_16x16x32_bf16 v[172:175], a[20:23], v[212:215], v[172:175]
    v_mfma_f32_16x16x32_bf16 v[176:179], a[44:47], v[212:215], v[176:179]
    v_mfma_f32_16x16x32_bf16 v[180:183], a[68:71], v[212:215], v[180:183]
    buffer_load_dwordx4 v88, s[20:23], s49 offen offset:0 lds
    s_waitcnt lgkmcnt(5)
    s_nop 0
    s_nop 0
    v_mfma_f32_16x16x32_bf16 v[184:187], a[92:95], v[212:215], v[184:187]
    s_nop 0
    v_cvt_pk_bf16_f32 v24, v172, v173
    s_waitcnt lgkmcnt(3)
    v_mfma_f32_16x16x32_bf16 v[188:191], a[116:119], v[212:215], v[188:191]
    v_cvt_pk_bf16_f32 v25, v174, v175
    v_cvt_pk_bf16_f32 v26, v176, v177
    v_mfma_f32_16x16x32_bf16 v[196:199], a[20:23], v[216:219], v[196:199]
    s_waitcnt lgkmcnt(1)
    v_cvt_pk_bf16_f32 v56, v184, v185
    v_cvt_pk_bf16_f32 v57, v186, v187
    v_mfma_f32_16x16x32_bf16 v[192:195], a[140:143], v[212:215], v[192:195]
    s_waitcnt vmcnt(10)
    ds_read_b128 v[212:215], v242 offset:0
    ds_read_b64_tr_b16 a[144:145], v91 offset:0
    buffer_load_dwordx4 v89, s[20:23], s49 offen offset:1024 lds
    v_mfma_f32_16x16x32_bf16 v[200:203], a[44:47], v[216:219], v[200:203]
    ds_read_b64_tr_b16 a[146:147], v91 offset:768
    ds_read_b64_tr_b16 a[168:169], v91 offset:32
    v_mfma_f32_16x16x32_bf16 v[204:207], a[68:71], v[216:219], v[204:207]
    ds_read_b64_tr_b16 a[170:171], v91 offset:800
    ds_read_b64_tr_b16 a[192:193], v91 offset:64
    v_mfma_f32_16x16x32_bf16 v[208:211], a[92:95], v[216:219], v[208:211]
    ds_read_b64_tr_b16 a[194:195], v91 offset:832
    buffer_load_dwordx4 v90, s[20:23], s49 offen offset:2048 lds
    s_add_u32 m0, s46, 94720
    s_mov_b32 s49, 61440
    v_mfma_f32_16x16x32_bf16 v[156:159], a[116:119], v[216:219], v[156:159]
    v_cvt_pk_bf16_f32 v58, v188, v189
    v_cvt_pk_bf16_f32 v59, v190, v191
    v_mfma_f32_16x16x32_bf16 v[160:163], a[140:143], v[216:219], v[160:163]
    ds_read_b128 v[216:219], v247 offset:0
    v_cvt_pk_bf16_f32 v0, v196, v197
    v_mfma_f32_16x16x32_bf16 v[164:167], a[20:23], v[220:223], v[164:167]
    v_cvt_pk_bf16_f32 v1, v198, v199
    v_cvt_pk_bf16_f32 v2, v200, v201
    v_mfma_f32_16x16x32_bf16 v[168:171], a[44:47], v[220:223], v[168:171]
    s_nop 0
    v_cvt_pk_bf16_f32 v3, v202, v203
    v_cvt_pk_bf16_f32 v27, v178, v179
    v_mfma_f32_16x16x32_bf16 v[124:127], a[68:71], v[220:223], v[124:127]
    s_nop 0
    v_cvt_pk_bf16_f32 v8, v164, v165
    v_cvt_pk_bf16_f32 v9, v166, v167
    v_mfma_f32_16x16x32_bf16 v[128:131], a[92:95], v[220:223], v[128:131]
    s_waitcnt lgkmcnt(8)
    v_cvt_pk_bf16_f32 v10, v168, v169
    v_cvt_pk_bf16_f32 v11, v170, v171
    v_mfma_f32_16x16x32_bf16 v[132:135], a[116:119], v[220:223], v[132:135]
    v_cvt_pk_bf16_f32 v12, v124, v125
    v_cvt_pk_bf16_f32 v13, v126, v127
    v_mfma_f32_16x16x32_bf16 v[136:139], a[140:143], v[220:223], v[136:139]
    s_waitcnt lgkmcnt(1)
    ds_read_b128 v[220:223], v247 offset:6144
    buffer_load_dwordx4 v88, s[20:23], s50 offen offset:0 lds
    s_waitcnt vmcnt(10)
    buffer_load_dwordx4 v89, s[20:23], s50 offen offset:1024 lds
    v_mfma_f32_16x16x32_bf16 v[140:143], a[20:23], v[224:227], v[140:143]
    ds_read_b64_tr_b16 a[148:149], v91 offset:12288
    ds_read_b64_tr_b16 a[150:151], v91 offset:13056
    v_mfma_f32_16x16x32_bf16 v[144:147], a[44:47], v[224:227], v[144:147]
    ds_read_b64_tr_b16 a[172:173], v91 offset:12320
    ds_read_b64_tr_b16 a[174:175], v91 offset:13088
    v_mfma_f32_16x16x32_bf16 v[148:151], a[68:71], v[224:227], v[148:151]
    ds_read_b64_tr_b16 a[196:197], v91 offset:12352
    ds_read_b64_tr_b16 a[198:199], v91 offset:13120
    buffer_load_dwordx4 v90, s[20:23], s50 offen offset:2048 lds
    s_mov_b32 m0, s88
    v_mfma_f32_16x16x32_bf16 v[152:155], a[92:95], v[224:227], v[152:155]
    ds_read_b128 v[124:127], v250 offset:9216
    v_cvt_pk_bf16_f32 v40, v128, v129
    v_mfma_f32_16x16x32_bf16 v[228:231], a[116:119], v[224:227], v[228:231]
    v_cvt_pk_bf16_f32 v41, v130, v131
    v_cvt_pk_bf16_f32 v42, v132, v133
    v_mfma_f32_16x16x32_bf16 v[232:235], a[140:143], v[224:227], v[232:235]
    ds_read_b128 v[224:227], v247 offset:12288
    s_waitcnt lgkmcnt(9)
    v_mfma_f32_16x16x32_bf16 v[172:175], v[216:219], a[144:147], 0
    buffer_load_dwordx4 v236, s[16:19], s42 offen nt lds
    s_add_u32 m0, m0, s89
    v_mfma_f32_16x16x32_bf16 v[176:179], v[216:219], a[168:171], 0
    ds_read_b128 v[128:131], v250 offset:10240
    s_waitcnt lgkmcnt(9)
    v_mfma_f32_16x16x32_bf16 v[184:187], v[220:223], a[144:147], 0
    v_cvt_pk_bf16_f32 v43, v134, v135
    v_cvt_pk_bf16_f32 v44, v136, v137
    v_mfma_f32_16x16x32_bf16 v[188:191], v[220:223], a[168:171], 0
L_pad1:
    s_cbranch_execz L_ret1
    ds_read_b128 v[132:135], v250 offset:11264
    ds_read_b32 v136, v250 offset:12300
    s_waitcnt vmcnt(10)
    ds_read_b64_tr_b16 a[152:153], v91 offset:24576
    ds_read_b64_tr_b16 a[154:155], v91 offset:25344
    ds_read_b64_tr_b16 a[176:177], v91 offset:24608
    ds_read_b64_tr_b16 a[178:179], v91 offset:25376
    ds_read_b64_tr_b16 a[200:201], v91 offset:24640
    s_waitcnt lgkmcnt(9)
    buffer_load_dwordx4 v237, s[16:19], s42 offen nt lds
    s_add_u32 m0, m0, s89
    v_mfma_f32_16x16x32_bf16 v[124:127], v[0:3], v[56:59], v[124:127]
    ds_read_b64_tr_b16 a[202:203], v91 offset:25408
    s_waitcnt lgkmcnt(9)
    v_mfma_f32_16x16x32_bf16 v[196:199], v[224:227], a[144:147], 0
    v_cvt_pk_bf16_f32 v16, v140, v141
    v_cvt_pk_bf16_f32 v17, v142, v143
    v_mfma_f32_16x16x32_bf16 v[200:203], v[224:227], a[168:171], 0
    s_waitcnt lgkmcnt(8)
    buffer_load_dwordx4 v238, s[16:19], s42 offen nt lds
    s_add_u32 m0, m0, s89
    v_mfma_f32_16x16x32_bf16 v[128:131], v[8:11], v[56:59], v[128:131]
    ds_read_b128 v[140:143], v250 offset:0
    v_cvt_pk_bf16_f32 v18, v144, v145
    v_cvt_pk_bf16_f32 v19, v146, v147
    v_cvt_pk_bf16_f32 v20, v148, v149
    s_waitcnt lgkmcnt(8)
    v_mfma_f32_16x16x32_bf16 v[132:135], v[16:19], v[56:59], v[132:135]
    s_waitcnt lgkmcnt(7)
    ds_read_b128 v[144:147], v250 offset:1024
    buffer_load_dwordx4 v239, s[16:19], s42 offen nt lds
    s_add_u32 m0, m0, s89
    v_cvt_pk_bf16_f32 v21, v150, v151
    v_cvt_pk_bf16_f32 v48, v152, v153
    v_cndmask_b32 v136, v254, v136, s[56:57]
    v_cvt_pk_bf16_f32 v45, v138, v139
    v_cvt_pk_bf16_f32 v60, v192, v193
    v_mfma_f32_16x16x32_bf16 v[136:139], v[24:27], v[56:59], v[136:139]
    ds_read_b128 v[148:151], v250 offset:2048
    ds_read_b32 v152, v250 offset:12288
    v_cvt_pk_bf16_f32 v61, v194, v195
    v_mfma_f32_16x16x32_bf16 v[192:195], v[220:223], a[192:195], 0
    ds_read_b128 v[220:223], v242 offset:128
    v_cvt_pk_bf16_f32 v4, v204, v205
    v_mfma_f32_16x16x32_bf16 v[128:131], v[12:15], v[60:63], v[128:131]
    s_mov_b64 exec, s[54:55]
    buffer_load_dwordx4 v240, s[16:19], s42 offen nt lds
    s_mov_b64 exec, -1
    s_add_u32 m0, s46, 119296
    v_mfma_f32_16x16x32_bf16 v[132:135], v[20:23], v[60:63], v[132:135]
    s_waitcnt vmcnt(11)
    ds_read_b64_tr_b16 a[156:157], v91 offset:36864
    ds_read_b64_tr_b16 a[158:159], v91 offset:37632
    ds_read_b64_tr_b16 a[180:181], v91 offset:36896
    ds_read_b64_tr_b16 a[182:183], v91 offset:37664
    ds_read_b64_tr_b16 a[204:205], v91 offset:36928
    ds_read_b64_tr_b16 a[206:207], v91 offset:37696
    v_cvt_pk_bf16_f32 v5, v206, v207
    v_mfma_f32_16x16x32_bf16 v[204:207], v[224:227], a[192:195], 0
    ds_read_b128 v[224:227], v247 offset:128
    v_cvt_pk_bf16_f32 v28, v180, v181
    v_mfma_f32_16x16x32_bf16 v[124:127], v[4:7], v[60:63], v[124:127]
    v_cvt_pk_bf16_f32 v29, v182, v183
    v_cvt_pk_bf16_f32 v32, v208, v209
    v_mfma_f32_16x16x32_bf16 v[180:183], v[216:219], a[192:195], 0
    ds_read_b128 v[216:219], v248 offset:12288
    v_cvt_pk_bf16_f32 v33, v210, v211
    v_mfma_f32_16x16x32_bf16 v[136:139], v[28:31], v[60:63], v[136:139]
    s_waitcnt lgkmcnt(9)
    v_cvt_pk_bf16_f32 v34, v156, v157
    v_cvt_pk_bf16_f32 v35, v158, v159
    v_mfma_f32_16x16x32_bf16 v[208:211], v[212:215], a[144:147], 0
    v_cndmask_b32 v152, v254, v152, s[56:57]
    v_cvt_pk_bf16_f32 v49, v154, v155
    v_mfma_f32_16x16x32_bf16 v[140:143], v[0:3], v[32:35], v[140:143]
    v_cvt_pk_bf16_f32 v36, v160, v161
    v_cvt_pk_bf16_f32 v37, v162, v163
    v_mfma_f32_16x16x32_bf16 v[144:147], v[8:11], v[32:35], v[144:147]
    v_cvt_pk_bf16_f32 v50, v228, v229
    v_cvt_pk_bf16_f32 v51, v230, v231
    v_mfma_f32_16x16x32_bf16 v[148:151], v[16:19], v[32:35], v[148:151]
    ds_read_b128 v[228:231], v242 offset:64
    v_cvt_pk_bf16_f32 v52, v232, v233
    v_mfma_f32_16x16x32_bf16 v[152:155], v[24:27], v[32:35], v[152:155]
    v_cvt_pk_bf16_f32 v53, v234, v235
    v_max3_f32 v137, v124, v125, v126
    v_mfma_f32_16x16x32_bf16 v[140:143], v[4:7], v[36:39], v[140:143]
    ds_read_b128 v[232:235], v248 offset:0
    v_max3_f32 v138, v127, v128, v129
    v_mfma_f32_16x16x32_bf16 v[144:147], v[12:15], v[36:39], v[144:147]
    s_waitcnt vmcnt(8)
    ds_read_b64_tr_b16 a[160:161], v91 offset:49152
    ds_read_b64_tr_b16 a[162:163], v91 offset:49920
    v_mfma_f32_16x16x32_bf16 v[148:151], v[20:23], v[36:39], v[148:151]
    ds_read_b64_tr_b16 a[184:185], v91 offset:49184
    ds_read_b64_tr_b16 a[186:187], v91 offset:49952
    v_mfma_f32_16x16x32_bf16 v[152:155], v[28:31], v[36:39], v[152:155]
    ds_read_b64_tr_b16 a[208:209], v91 offset:49216
    ds_read_b64_tr_b16 a[210:211], v91 offset:49984
    v_mfma_f32_16x16x32_bf16 v[156:159], v[212:215], a[168:171], 0
    v_max3_f32 v137, v137, v130, v131
    v_max3_f32 v138, v138, v132, v133
    v_mfma_f32_16x16x32_bf16 v[160:163], v[212:215], a[192:195], 0
    ds_read_b128 v[212:215], v248 offset:6144
    s_waitcnt lgkmcnt(9)
    v_mfma_f32_16x16x32_bf16 v[196:199], v[216:219], a[148:151], v[196:199]
    s_waitcnt lgkmcnt(8)
    v_max3_f32 v137, v137, v134, v135
    v_mfma_f32_16x16x32_bf16 v[208:211], v[228:231], a[148:151], v[208:211]
    v_max3_f32 v137, v137, v138, v136
    v_mov_b32 v138, v137
    v_mfma_f32_16x16x32_bf16 v[156:159], v[228:231], a[172:175], v[156:159]
    s_waitcnt lgkmcnt(7)
    v_mov_b32 v88, 0x3f803f80
    v_mfma_f32_16x16x32_bf16 v[160:163], v[228:231], a[196:199], v[160:163]
    ds_read_b128 v[228:231], v247 offset:6272
    v_cndmask_b32 v89, 0, v88, s[72:73]
    v_mfma_f32_16x16x32_bf16 v[172:175], v[232:235], a[148:151], v[172:175]
    v_permlane32_swap_b32 v137, v138
    v_mfma_f32_16x16x32_bf16 v[176:179], v[232:235], a[172:175], v[176:179]
    v_max_f32 v137, v137, v138
    v_mov_b32 v138, v137
    v_mfma_f32_16x16x32_bf16 v[180:183], v[232:235], a[196:199], v[180:183]
    ds_read_b128 v[232:235], v247 offset:12416
    v_cndmask_b32 v90, 0, v88, s[72:73]
    v_mfma_f32_16x16x32_bf16 v[200:203], v[216:219], a[172:175], v[200:203]
    buffer_load_dwordx4 v244, s[24:27], s51 offen offset:0 lds
    s_waitcnt lgkmcnt(2)
    buffer_load_dwordx4 v245, s[24:27], s51 offen offset:1024 lds
    v_mfma_f32_16x16x32_bf16 v[184:187], v[212:215], a[148:151], v[184:187]
    s_waitcnt vmcnt(7)
    ds_read_b64_tr_b16 a[164:165], v91 offset:0
    ds_read_b64_tr_b16 a[166:167], v91 offset:768
    v_mfma_f32_16x16x32_bf16 v[188:191], v[212:215], a[172:175], v[188:191]
    ds_read_b64_tr_b16 a[188:189], v91 offset:32
    ds_read_b64_tr_b16 a[190:191], v91 offset:800
    v_mfma_f32_16x16x32_bf16 v[192:195], v[212:215], a[196:199], v[192:195]
    ds_read_b128 v[212:215], v242 offset:192
    ds_read_b64_tr_b16 a[212:213], v91 offset:64
    v_mfma_f32_16x16x32_bf16 v[204:207], v[216:219], a[196:199], v[204:207]
    ds_read_b128 v[216:219], v248 offset:128
    ds_read_b64_tr_b16 a[214:215], v91 offset:832
    v_mfma_f32_16x16x32_bf16 v[208:211], v[220:223], a[152:155], v[208:211]
    buffer_load_dwordx4 v246, s[24:27], s51 offen offset:2048 lds
    s_add_u32 m0, s46, 131584
    v_mfma_f32_16x16x32_bf16 v[156:159], v[220:223], a[176:179], v[156:159]
    v_permlane16_swap_b32 v137, v138
    v_mfma_f32_16x16x32_bf16 v[160:163], v[220:223], a[200:203], v[160:163]
    ds_read_b128 v[220:223], v248 offset:6272
    v_max_f32 v137, v137, v138
    v_mfma_f32_16x16x32_bf16 v[172:175], v[224:227], a[152:155], v[172:175]
    s_waitcnt lgkmcnt(10)
    v_mul_f32 v137, s38, v137
    v_fma_f32 v124, v124, s38, -v137
    v_mfma_f32_16x16x32_bf16 v[176:179], v[224:227], a[176:179], v[176:179]
    v_fma_f32 v125, v125, s38, -v137
    v_fma_f32 v126, v126, s38, -v137
    v_mfma_f32_16x16x32_bf16 v[180:183], v[224:227], a[200:203], v[180:183]
    ds_read_b128 v[224:227], v248 offset:12416
    v_fma_f32 v127, v127, s38, -v137
    v_mfma_f32_16x16x32_bf16 v[184:187], v[228:231], a[152:155], v[184:187]
    s_waitcnt lgkmcnt(10)
    v_exp_f32 v124, v124
    v_mfma_f32_16x16x32_bf16 v[188:191], v[228:231], a[176:179], v[188:191]
    v_exp_f32 v125, v125
    v_mfma_f32_16x16x32_bf16 v[192:195], v[228:231], a[200:203], v[192:195]
    ds_read_b128 v[228:231], v242 offset:256
    v_fma_f32 v128, v128, s38, -v137
    v_mfma_f32_16x16x32_bf16 v[196:199], v[232:235], a[152:155], v[196:199]
    s_waitcnt lgkmcnt(6)
    v_fma_f32 v129, v129, s38, -v137
    v_fma_f32 v130, v130, s38, -v137
    v_mfma_f32_16x16x32_bf16 v[200:203], v[232:235], a[176:179], v[200:203]
    buffer_load_dwordx4 v244, s[24:27], s52 offen offset:0 lds
    buffer_load_dwordx4 v245, s[24:27], s52 offen offset:1024 lds
    v_mfma_f32_16x16x32_bf16 v[204:207], v[232:235], a[200:203], v[204:207]
    ds_read_b128 v[232:235], v247 offset:256
    v_fma_f32 v131, v131, s38, -v137
    v_mfma_f32_16x16x32_bf16 v[208:211], v[212:215], a[156:159], v[208:211]
    s_waitcnt lgkmcnt(5)
    v_exp_f32 v126, v126
    v_mfma_f32_16x16x32_bf16 v[156:159], v[212:215], a[180:183], v[156:159]
    buffer_load_dwordx4 v246, s[24:27], s52 offen offset:2048 lds
    s_add_u32 m0, s46, 143872
    v_mfma_f32_16x16x32_bf16 v[160:163], v[212:215], a[204:207], v[160:163]
    ds_read_b128 v[212:215], v247 offset:6400
    v_cvt_pk_bf16_f32 v124, v124, v125
    v_mfma_f32_16x16x32_bf16 v[172:175], v[216:219], a[156:159], v[172:175]
    s_waitcnt lgkmcnt(4)
    v_exp_f32 v127, v127
    v_mfma_f32_16x16x32_bf16 v[176:179], v[216:219], a[180:183], v[176:179]
    v_exp_f32 v128, v128
    v_mfma_f32_16x16x32_bf16 v[180:183], v[216:219], a[204:207], v[180:183]
    ds_read_b128 v[216:219], v247 offset:12544
    v_cndmask_b32 v91, 0, v88, s[72:73]
    v_mfma_f32_16x16x32_bf16 v[184:187], v[220:223], a[156:159], v[184:187]
    s_waitcnt lgkmcnt(4)
    v_exp_f32 v129, v129
    v_mfma_f32_16x16x32_bf16 v[188:191], v[220:223], a[180:183], v[188:191]
    v_exp_f32 v130, v130
    v_mfma_f32_16x16x32_bf16 v[192:195], v[220:223], a[204:207], v[192:195]
    ds_read_b128 v[220:223], v242 offset:320
    v_cvt_pk_bf16_f32 v125, v126, v127
    v_mfma_f32_16x16x32_bf16 v[196:199], v[224:227], a[156:159], v[196:199]
    s_waitcnt lgkmcnt(4)
    v_exp_f32 v131, v131
    v_mfma_f32_16x16x32_bf16 v[200:203], v[224:227], a[180:183], v[200:203]
    v_cndmask_b32 v88, 0, v88, s[72:73]
    v_cvt_pk_bf16_f32 v126, v128, v129
    v_mfma_f32_16x16x32_bf16 v[204:207], v[224:227], a[204:207], v[204:207]
    ds_read_b128 v[224:227], v248 offset:256
    v_cvt_pk_bf16_f32 v127, v130, v131
    v_mfma_f32_16x16x32_bf16 v[208:211], v[228:231], a[160:163], v[208:211]
    s_waitcnt lgkmcnt(4)
    v_fma_f32 v132, v132, s38, -v137
    v_fma_f32 v133, v133, s38, -v137
    v_mfma_f32_16x16x32_bf16 v[156:159], v[228:231], a[184:187], v[156:159]
    v_fma_f32 v134, v134, s38, -v137
    v_fma_f32 v135, v135, s38, -v137
    v_mfma_f32_16x16x32_bf16 v[160:163], v[228:231], a[208:211], v[160:163]
    ds_read_b128 v[228:231], v248 offset:6400
    v_fma_f32 v136, v136, s38, -v137
    v_mfma_f32_16x16x32_bf16 v[172:175], v[232:235], a[160:163], v[172:175]
    s_waitcnt lgkmcnt(4)
    v_exp_f32 v132, v132
    v_mfma_f32_16x16x32_bf16 v[176:179], v[232:235], a[184:187], v[176:179]
    v_exp_f32 v133, v133
    v_mfma_f32_16x16x32_bf16 v[180:183], v[232:235], a[208:211], v[180:183]
    ds_read_b128 v[232:235], v248 offset:12544
    v_cvt_pk_bf16_f32 v128, v132, v133
    v_mfma_f32_16x16x32_bf16 v[184:187], v[212:215], a[160:163], v[184:187]
    s_waitcnt lgkmcnt(4)
    v_exp_f32 v134, v134
    v_mfma_f32_16x16x32_bf16 v[188:191], v[212:215], a[184:187], v[188:191]
    v_exp_f32 v135, v135
    v_mfma_f32_16x16x32_bf16 v[192:195], v[212:215], a[208:211], v[192:195]
    v_cvt_pk_bf16_f32 v129, v134, v135
    v_max3_f32 v153, v140, v141, v142
    v_mfma_f32_16x16x32_bf16 v[196:199], v[216:219], a[160:163], v[196:199]
    s_waitcnt lgkmcnt(3)
    v_exp_f32 v136, v136
    v_mfma_f32_16x16x32_bf16 v[200:203], v[216:219], a[184:187], v[200:203]
    v_max3_f32 v154, v143, v144, v145
    v_max3_f32 v153, v153, v146, v147
    v_mfma_f32_16x16x32_bf16 v[204:207], v[216:219], a[208:211], v[204:207]
    v_max3_f32 v154, v154, v148, v149
    v_max3_f32 v153, v153, v150, v151
    v_mfma_f32_16x16x32_bf16 v[208:211], v[220:223], a[164:167], v[208:211]
    s_waitcnt lgkmcnt(2)
    v_cvt_pk_bf16_f32 v130, v136, 0
    v_max3_f32 v153, v153, v154, v152
    v_mfma_f32_16x16x32_bf16 v[156:159], v[220:223], a[188:191], v[156:159]
    v_mov_b32 v154, v153
    v_mov_b32 v131, 0
    v_mfma_f32_16x16x32_bf16 v[160:163], v[220:223], a[212:215], v[160:163]
    s_nop 0
    v_permlane32_swap_b32 v153, v154
    s_nop 0
    v_mfma_f32_16x16x32_bf16 v[172:175], v[224:227], a[164:167], v[172:175]
    s_waitcnt lgkmcnt(1)
    v_cvt_pk_bf16_f32 v78, v156, v157
    v_cvt_pk_bf16_f32 v79, v158, v159
    v_mfma_f32_16x16x32_bf16 v[176:179], v[224:227], a[188:191], v[176:179]
    v_cvt_pk_bf16_f32 v86, v160, v161
    v_cvt_pk_bf16_f32 v87, v162, v163
    v_mfma_f32_16x16x32_bf16 v[180:183], v[224:227], a[212:215], v[180:183]
    s_nop 0
    v_cvt_pk_bf16_f32 v64, v172, v173
    v_cvt_pk_bf16_f32 v65, v174, v175
    v_mfma_f32_16x16x32_bf16 v[184:187], v[228:231], a[164:167], v[184:187]
    s_waitcnt lgkmcnt(0)
    v_cvt_pk_bf16_f32 v72, v176, v177
    v_cvt_pk_bf16_f32 v73, v178, v179
    v_mfma_f32_16x16x32_bf16 v[188:191], v[228:231], a[188:191], v[188:191]
    s_barrier
    v_cvt_pk_bf16_f32 v80, v180, v181
    v_cvt_pk_bf16_f32 v81, v182, v183
    v_mfma_f32_16x16x32_bf16 v[192:195], v[228:231], a[212:215], v[192:195]
    v_cvt_pk_bf16_f32 v66, v184, v185
    v_cvt_pk_bf16_f32 v67, v186, v187
    v_mfma_f32_16x16x32_bf16 v[196:199], v[232:235], a[164:167], v[196:199]
    s_nop 0
    v_cvt_pk_bf16_f32 v74, v188, v189
    v_cvt_pk_bf16_f32 v75, v190, v191
    v_mfma_f32_16x16x32_bf16 v[200:203], v[232:235], a[188:191], v[200:203]
    s_nop 0
    v_cvt_pk_bf16_f32 v82, v192, v193
    v_cvt_pk_bf16_f32 v83, v194, v195
    v_mfma_f32_16x16x32_bf16 v[204:207], v[232:235], a[212:215], v[204:207]
    v_max_f32 v153, v153, v154
    v_mov_b32 v154, v153
    v_mfma_f32_16x16x32_bf16 v[160:163], v[88:91], v[124:127], 0
    v_cvt_pk_bf16_f32 v70, v208, v209
    v_cvt_pk_bf16_f32 v71, v210, v211
    v_mfma_f32_16x16x32_bf16 v[132:135], v[64:67], v[124:127], 0
    v_cvt_pk_bf16_f32 v68, v196, v197
    v_cvt_pk_bf16_f32 v69, v198, v199
    v_mfma_f32_16x16x32_bf16 v[136:139], v[72:75], v[124:127], 0
    v_permlane16_swap_b32 v153, v154
    v_mfma_f32_16x16x32_bf16 v[156:159], v[80:83], v[124:127], 0
    v_cvt_pk_bf16_f32 v76, v200, v201
    v_cvt_pk_bf16_f32 v77, v202, v203
    v_mfma_f32_16x16x32_bf16 v[160:163], v[88:91], v[128:131], v[160:163]
    v_max_f32 v153, v153, v154
    v_mul_f32 v153, s38, v153
    v_mfma_f32_16x16x32_bf16 v[132:135], v[68:71], v[128:131], v[132:135]
    v_fma_f32 v140, v140, s38, -v153
    v_fma_f32 v141, v141, s38, -v153
    v_mfma_f32_16x16x32_bf16 v[136:139], v[76:79], v[128:131], v[136:139]
    v_fma_f32 v142, v142, s38, -v153
    v_fma_f32 v143, v143, s38, -v153
    v_exp_f32 v140, v140
    v_exp_f32 v141, v141
    v_cvt_pk_bf16_f32 v84, v204, v205
    v_cvt_pk_bf16_f32 v85, v206, v207
    v_fma_f32 v144, v144, s38, -v153
    v_fma_f32 v145, v145, s38, -v153
    v_mfma_f32_16x16x32_bf16 v[156:159], v[84:87], v[128:131], v[156:159]
    v_fma_f32 v146, v146, s38, -v153
    v_fma_f32 v147, v147, s38, -v153
    v_exp_f32 v142, v142
    v_exp_f32 v143, v143
    v_exp_f32 v144, v144
    v_exp_f32 v145, v145
    v_exp_f32 v146, v146
    v_exp_f32 v147, v147
    v_cvt_pk_bf16_f32 v140, v140, v141
    v_cvt_pk_bf16_f32 v141, v142, v143
    v_cvt_pk_bf16_f32 v142, v144, v145
    v_cvt_pk_bf16_f32 v143, v146, v147
    v_rcp_f32 v160, v160
    s_nop 0
    v_mfma_f32_16x16x32_bf16 v[168:171], v[88:91], v[140:143], 0
    v_fma_f32 v148, v148, s38, -v153
    v_fma_f32 v149, v149, s38, -v153
    v_mfma_f32_16x16x32_bf16 v[164:167], v[80:83], v[140:143], 0
    v_fma_f32 v150, v150, s38, -v153
    v_fma_f32 v151, v151, s38, -v153
    v_exp_f32 v148, v148
    v_exp_f32 v149, v149
    v_exp_f32 v150, v150
    v_exp_f32 v151, v151
    v_mul_f32 v132, v132, v160
    v_mul_f32 v133, v133, v160
    v_mul_f32 v134, v134, v160
    v_mul_f32 v135, v135, v160
    v_cvt_pk_bf16_f32 v132, v132, v133
    v_fma_f32 v152, v152, s38, -v153
    v_mul_f32 v136, v136, v160
    v_mul_f32 v137, v137, v160
    v_mul_f32 v138, v138, v160
    v_mul_f32 v139, v139, v160
    v_cvt_pk_bf16_f32 v144, v148, v149
    v_cvt_pk_bf16_f32 v145, v150, v151
    v_mfma_f32_16x16x32_bf16 v[148:151], v[64:67], v[140:143], 0
    ds_read_b128 v[124:127], v250 offset:3072
    v_cvt_pk_bf16_f32 v133, v134, v135
    v_exp_f32 v152, v152
    v_cvt_pk_bf16_f32 v134, v136, v137
    v_cvt_pk_bf16_f32 v135, v138, v139
    v_cvt_pk_bf16_f32 v146, v152, 0
    v_mfma_f32_16x16x32_bf16 v[152:155], v[72:75], v[140:143], 0
    s_mov_b64 exec, s[64:65]
    ds_write_b128 v251, v[132:135] offset:0
    s_mov_b64 exec, -1
    ds_read_b128 v[128:131], v250 offset:4096
    ds_read_b128 v[132:135], v250 offset:5120
    ds_read_b32 v136, v250 offset:12292
    v_mov_b32 v147, 0
    v_mul_f32 v156, v156, v160
    v_mul_f32 v157, v157, v160
    v_mfma_f32_16x16x32_bf16 v[168:171], v[88:91], v[144:147], v[168:171]
    ds_read_b128 v[140:143], v250 offset:6144
    v_mul_f32 v158, v158, v160
    v_mfma_f32_16x16x32_bf16 v[148:151], v[68:71], v[144:147], v[148:151]
    s_nop 0
    v_mul_f32 v159, v159, v160
    v_cvt_pk_bf16_f32 v156, v156, v157
    v_mfma_f32_16x16x32_bf16 v[152:155], v[76:79], v[144:147], v[152:155]
    s_nop 0
    v_rcp_f32 v168, v168
    s_waitcnt lgkmcnt(5)
    v_mfma_f32_16x16x32_bf16 v[164:167], v[84:87], v[144:147], v[164:167]
    v_mul_f32 v148, v148, v168
    v_mul_f32 v149, v149, v168
    v_mfma_f32_16x16x32_bf16 v[124:127], v[0:3], v[40:43], v[124:127]
    v_mul_f32 v150, v150, v168
    v_mul_f32 v151, v151, v168
    v_mfma_f32_16x16x32_bf16 v[124:127], v[4:7], v[44:47], v[124:127]
    v_cvt_pk_bf16_f32 v148, v148, v149
    v_mul_f32 v152, v152, v168
    v_mul_f32 v153, v153, v168
    v_mul_f32 v154, v154, v168
    v_mul_f32 v155, v155, v168
    v_cvt_pk_bf16_f32 v149, v150, v151
    v_cvt_pk_bf16_f32 v150, v152, v153
    v_cvt_pk_bf16_f32 v151, v154, v155
    v_cvt_pk_bf16_f32 v157, v158, v159
    v_mul_f32 v164, v164, v168
    v_mul_f32 v165, v165, v168
    s_waitcnt lgkmcnt(3)
    v_mfma_f32_16x16x32_bf16 v[128:131], v[8:11], v[40:43], v[128:131]
    ds_read_b128 v[144:147], v250 offset:7168
    s_waitcnt lgkmcnt(3)
    buffer_load_dwordx4 v244, s[24:27], s53 offen offset:0 lds
    s_waitcnt lgkmcnt(2)
    ds_write_b128 v251, v[148:151] offset:6144
    v_mfma_f32_16x16x32_bf16 v[132:135], v[16:19], v[40:43], v[132:135]
    ds_read_b128 v[148:151], v250 offset:8192
    v_cndmask_b32 v136, v254, v136, s[56:57]
    v_mfma_f32_16x16x32_bf16 v[128:131], v[12:15], v[44:47], v[128:131]
    ds_read_b32 v152, v250 offset:12296
    v_mul_f32 v166, v166, v168
    v_mfma_f32_16x16x32_bf16 v[136:139], v[24:27], v[40:43], v[136:139]
    s_waitcnt lgkmcnt(4)
    v_mul_f32 v167, v167, v168
    v_cvt_pk_bf16_f32 v164, v164, v165
    v_mfma_f32_16x16x32_bf16 v[132:135], v[20:23], v[44:47], v[132:135]
    buffer_load_dwordx4 v245, s[24:27], s53 offen offset:1024 lds
    v_mfma_f32_16x16x32_bf16 v[136:139], v[28:31], v[44:47], v[136:139]
    v_cvt_pk_bf16_f32 v165, v166, v167
    s_waitcnt lgkmcnt(3)
    v_mfma_f32_16x16x32_bf16 v[140:143], v[0:3], v[48:51], v[140:143]
    v_mfma_f32_16x16x32_bf16 v[144:147], v[8:11], v[48:51], v[144:147]
    buffer_load_dwordx4 v246, s[24:27], s53 offen offset:2048 lds
    s_mov_b32 m0, s45
    v_mfma_f32_16x16x32_bf16 v[140:143], v[4:7], v[52:55], v[140:143]
    s_nop 0
    v_max3_f32 v137, v124, v125, v126
    v_max3_f32 v138, v127, v128, v129
    v_mfma_f32_16x16x32_bf16 v[144:147], v[12:15], v[52:55], v[144:147]
    v_max3_f32 v137, v137, v130, v131
    v_max3_f32 v138, v138, v132, v133
    s_waitcnt lgkmcnt(1)
    v_mfma_f32_16x16x32_bf16 v[148:151], v[16:19], v[48:51], v[148:151]
    s_waitcnt lgkmcnt(0)
    v_cndmask_b32 v152, v254, v152, s[56:57]
    v_mfma_f32_16x16x32_bf16 v[148:151], v[20:23], v[52:55], v[148:151]
    buffer_load_dwordx4 v236, s[16:19], s43 offen nt lds
    s_add_u32 m0, m0, s89
    v_mfma_f32_16x16x32_bf16 v[152:155], v[24:27], v[48:51], v[152:155]
    v_max3_f32 v137, v137, v134, v135
    v_max3_f32 v137, v137, v138, v136
    v_mfma_f32_16x16x32_bf16 v[152:155], v[28:31], v[52:55], v[152:155]
    v_mov_b32 v138, v137
    s_nop 1
    v_permlane32_swap_b32 v137, v138
    s_waitcnt vmcnt(7)
    ds_read_b64_tr_b16 a[216:217], v241 offset:24576
    ds_read_b64_tr_b16 a[240:241], v241 offset:24584
    ds_read_b64_tr_b16 v[100:101], v255 offset:24576
    ds_read_b64_tr_b16 a[218:219], v241 offset:26112
    ds_read_b64_tr_b16 a[242:243], v241 offset:26120
    ds_read_b64_tr_b16 v[102:103], v255 offset:26112
    buffer_load_dwordx4 v237, s[16:19], s43 offen nt lds
    s_add_u32 m0, m0, s89
    s_barrier
    s_waitcnt vmcnt(5)
    buffer_load_dwordx4 v238, s[16:19], s43 offen nt lds
    s_add_u32 m0, m0, s89
    ds_read_b64_tr_b16 a[232:233], v241 offset:36864
    ds_read_b64_tr_b16 v[92:93], v241 offset:36872
    ds_read_b64_tr_b16 v[116:117], v255 offset:36864
    ds_read_b64_tr_b16 a[220:221], v241 offset:38400
    ds_read_b64_tr_b16 a[244:245], v241 offset:38408
    ds_read_b64_tr_b16 v[104:105], v255 offset:38400
    ds_read_b128 v[212:215], v247 offset:18432
    ds_read_b128 v[216:219], v248 offset:18432
    ds_read_b128 v[220:223], v247 offset:18560
    buffer_load_dwordx4 v239, s[16:19], s43 offen nt lds
    s_add_u32 m0, m0, s89
    v_max_f32 v137, v137, v138
    v_mov_b32 v138, v137
    s_nop 1
    v_permlane16_swap_b32 v137, v138
    s_nop 0
    v_max_f32 v137, v137, v138
    v_mul_f32 v137, s38, v137
    v_fma_f32 v124, v124, s38, -v137
    v_fma_f32 v125, v125, s38, -v137
    s_mov_b64 exec, s[54:55]
    buffer_load_dwordx4 v240, s[16:19], s43 offen nt lds
    s_mov_b64 exec, -1
    s_add_u32 m0, s46, 119296
    v_fma_f32 v126, v126, s38, -v137
    v_fma_f32 v127, v127, s38, -v137
    v_exp_f32 v124, v124
    s_waitcnt lgkmcnt(9)
    v_exp_f32 v125, v125
    buffer_load_dwordx4 v244, s[24:27], s47 offen offset:0 lds
    v_fma_f32 v128, v128, s38, -v137
    v_fma_f32 v129, v129, s38, -v137
    v_fma_f32 v130, v130, s38, -v137
    v_fma_f32 v131, v131, s38, -v137
    v_exp_f32 v126, v126
    v_exp_f32 v127, v127
    v_exp_f32 v128, v128
    v_exp_f32 v129, v129
    s_waitcnt lgkmcnt(2)
    v_mfma_f32_16x16x32_bf16 v[172:175], a[0:3], v[212:215], 0
    buffer_load_dwordx4 v245, s[24:27], s47 offen offset:1024 lds
    v_mfma_f32_16x16x32_bf16 v[176:179], a[24:27], v[212:215], 0
    v_exp_f32 v130, v130
    v_mfma_f32_16x16x32_bf16 v[180:183], a[48:51], v[212:215], 0
    v_exp_f32 v131, v131
    v_mfma_f32_16x16x32_bf16 v[184:187], a[72:75], v[212:215], 0
    s_waitcnt lgkmcnt(1)
    v_cvt_pk_bf16_f32 v124, v124, v125
    v_cvt_pk_bf16_f32 v125, v126, v127
    v_mfma_f32_16x16x32_bf16 v[188:191], a[96:99], v[212:215], 0
    buffer_load_dwordx4 v246, s[24:27], s47 offen offset:2048 lds
    s_add_u32 m0, s46, 131584
    v_mfma_f32_16x16x32_bf16 v[192:195], a[120:123], v[212:215], 0
    v_cvt_pk_bf16_f32 v126, v128, v129
    v_cvt_pk_bf16_f32 v127, v130, v131
    v_mfma_f32_16x16x32_bf16 v[172:175], a[4:7], v[216:219], v[172:175]
    v_fma_f32 v132, v132, s38, -v137
    v_fma_f32 v133, v133, s38, -v137
    v_mfma_f32_16x16x32_bf16 v[176:179], a[28:31], v[216:219], v[176:179]
    v_fma_f32 v134, v134, s38, -v137
    v_fma_f32 v135, v135, s38, -v137
    v_mfma_f32_16x16x32_bf16 v[180:183], a[52:55], v[216:219], v[180:183]
    ds_read_b128 v[224:227], v248 offset:18560
    v_fma_f32 v136, v136, s38, -v137
    v_mfma_f32_16x16x32_bf16 v[184:187], a[76:79], v[216:219], v[184:187]
    s_waitcnt lgkmcnt(1)
    v_exp_f32 v132, v132
    v_mfma_f32_16x16x32_bf16 v[188:191], a[100:103], v[216:219], v[188:191]
    buffer_load_dwordx4 v244, s[24:27], s48 offen offset:0 lds
    v_mfma_f32_16x16x32_bf16 v[192:195], a[124:127], v[216:219], v[192:195]
    v_exp_f32 v133, v133
    v_mfma_f32_16x16x32_bf16 v[172:175], a[8:11], v[220:223], v[172:175]
    v_exp_f32 v134, v134
    v_mfma_f32_16x16x32_bf16 v[176:179], a[32:35], v[220:223], v[176:179]
    v_exp_f32 v135, v135
    v_mfma_f32_16x16x32_bf16 v[180:183], a[56:59], v[220:223], v[180:183]
    s_mov_b64 exec, s[64:65]
    ds_write_b64 v252, v[156:157] offset:0
    s_mov_b64 exec, -1
    buffer_load_dwordx4 v245, s[24:27], s48 offen offset:1024 lds
    v_mfma_f32_16x16x32_bf16 v[184:187], a[80:83], v[220:223], v[184:187]
    v_cvt_pk_bf16_f32 v128, v132, v133
    v_cvt_pk_bf16_f32 v129, v134, v135
    v_mfma_f32_16x16x32_bf16 v[188:191], a[104:107], v[220:223], v[188:191]
    v_exp_f32 v136, v136
    v_mfma_f32_16x16x32_bf16 v[192:195], a[128:131], v[220:223], v[192:195]
    v_cvt_pk_bf16_f32 v130, v136, 0
    v_mov_b32 v131, 0
    v_mfma_f32_16x16x32_bf16 v[160:163], v[88:91], v[124:127], 0
    s_waitcnt vmcnt(10)
    ds_read_b64_tr_b16 a[222:223], v241 offset:49152
    v_mfma_f32_16x16x32_bf16 v[132:135], v[64:67], v[124:127], 0
    ds_read_b64_tr_b16 a[246:247], v241 offset:49160
    ds_read_b64_tr_b16 v[106:107], v255 offset:49152
    v_mfma_f32_16x16x32_bf16 v[136:139], v[72:75], v[124:127], 0
    ds_read_b64_tr_b16 a[234:235], v241 offset:50688
    ds_read_b64_tr_b16 v[94:95], v241 offset:50696
    v_mfma_f32_16x16x32_bf16 v[156:159], v[80:83], v[124:127], 0
    ds_read_b64_tr_b16 v[118:119], v255 offset:50688
    ds_read_b128 v[228:231], v247 offset:18688
    v_mfma_f32_16x16x32_bf16 v[160:163], v[88:91], v[128:131], v[160:163]
    buffer_load_dwordx4 v246, s[24:27], s48 offen offset:2048 lds
    s_add_u32 m0, s46, 143872
    v_mfma_f32_16x16x32_bf16 v[132:135], v[68:71], v[128:131], v[132:135]
    s_waitcnt lgkmcnt(8)
    ds_read_b128 v[232:235], v248 offset:18688
    v_max3_f32 v153, v140, v141, v142
    v_mfma_f32_16x16x32_bf16 v[136:139], v[76:79], v[128:131], v[136:139]
    v_max3_f32 v154, v143, v144, v145
    v_max3_f32 v153, v153, v146, v147
    v_mfma_f32_16x16x32_bf16 v[156:159], v[84:87], v[128:131], v[156:159]
    v_max3_f32 v154, v154, v148, v149
    v_max3_f32 v153, v153, v150, v151
    v_mfma_f32_16x16x32_bf16 v[172:175], a[12:15], v[224:227], v[172:175]
    v_max3_f32 v153, v153, v154, v152
    v_mov_b32 v154, v153
    v_mfma_f32_16x16x32_bf16 v[176:179], a[36:39], v[224:227], v[176:179]
    s_nop 0
    v_permlane32_swap_b32 v153, v154
    v_mfma_f32_16x16x32_bf16 v[180:183], a[60:63], v[224:227], v[180:183]
    v_max_f32 v153, v153, v154
    v_mov_b32 v154, v153
    v_mfma_f32_16x16x32_bf16 v[184:187], a[84:87], v[224:227], v[184:187]
    s_nop 0
    v_permlane16_swap_b32 v153, v154
    s_waitcnt lgkmcnt(2)
    v_mfma_f32_16x16x32_bf16 v[188:191], a[108:111], v[224:227], v[188:191]
    v_max_f32 v153, v153, v154
    v_mul_f32 v153, s38, v153
    v_mfma_f32_16x16x32_bf16 v[192:195], a[132:135], v[224:227], v[192:195]
    s_waitcnt lgkmcnt(1)
    v_fma_f32 v140, v140, s38, -v153
    v_fma_f32 v141, v141, s38, -v153
    v_mfma_f32_16x16x32_bf16 v[172:175], a[16:19], v[228:231], v[172:175]
    v_fma_f32 v142, v142, s38, -v153
    v_fma_f32 v143, v143, s38, -v153
    v_mfma_f32_16x16x32_bf16 v[176:179], a[40:43], v[228:231], v[176:179]
L_pad2:
    s_cbranch_execz L_ret2
    v_exp_f32 v140, v140
    v_mfma_f32_16x16x32_bf16 v[180:183], a[64:67], v[228:231], v[180:183]
    v_exp_f32 v141, v141
    v_mfma_f32_16x16x32_bf16 v[184:187], a[88:91], v[228:231], v[184:187]
    s_waitcnt lgkmcnt(0)
    v_fma_f32 v144, v144, s38, -v153
    v_fma_f32 v145, v145, s38, -v153
    v_mfma_f32_16x16x32_bf16 v[188:191], a[112:115], v[228:231], v[188:191]
    v_fma_f32 v146, v146, s38, -v153
    v_fma_f32 v147, v147, s38, -v153
    v_mfma_f32_16x16x32_bf16 v[192:195], a[136:139], v[228:231], v[192:195]
    v_exp_f32 v142, v142
    v_mfma_f32_16x16x32_bf16 v[172:175], a[20:23], v[232:235], v[172:175]
    v_exp_f32 v143, v143
    v_mfma_f32_16x16x32_bf16 v[176:179], a[44:47], v[232:235], v[176:179]
    v_exp_f32 v144, v144
    v_mfma_f32_16x16x32_bf16 v[180:183], a[68:71], v[232:235], v[180:183]
    v_exp_f32 v145, v145
    v_mfma_f32_16x16x32_bf16 v[184:187], a[92:95], v[232:235], v[184:187]
    v_exp_f32 v146, v146
    v_mfma_f32_16x16x32_bf16 v[188:191], a[116:119], v[232:235], v[188:191]
    v_exp_f32 v147, v147
    v_mfma_f32_16x16x32_bf16 v[192:195], a[140:143], v[232:235], v[192:195]
    v_cvt_pk_bf16_f32 v140, v140, v141
    v_cvt_pk_bf16_f32 v141, v142, v143
    v_cvt_pk_bf16_f32 v142, v144, v145
    v_cvt_pk_bf16_f32 v143, v146, v147
    v_fma_f32 v148, v148, s38, -v153
    v_fma_f32 v149, v149, s38, -v153
    v_mfma_f32_16x16x32_bf16 v[168:171], v[88:91], v[140:143], 0
    v_fma_f32 v150, v150, s38, -v153
    v_fma_f32 v151, v151, s38, -v153
    v_exp_f32 v148, v148
    v_exp_f32 v149, v149
    v_exp_f32 v150, v150
    v_exp_f32 v151, v151
    v_fma_f32 v152, v152, s38, -v153
    v_cvt_pk_bf16_f32 v144, v148, v149
    v_cvt_pk_bf16_f32 v145, v150, v151
    v_mfma_f32_16x16x32_bf16 v[148:151], v[64:67], v[140:143], 0
    ds_read_b128 v[212:215], v247 offset:24576
    v_exp_f32 v152, v152
    v_mov_b32 v147, 0
    v_cvt_pk_bf16_f32 v146, v152, 0
    v_mfma_f32_16x16x32_bf16 v[152:155], v[72:75], v[140:143], 0
    ds_write_b64 v252, v[164:165] offset:6144
    v_mfma_f32_16x16x32_bf16 v[164:167], v[80:83], v[140:143], 0
    ds_read_b128 v[216:219], v248 offset:24576
    v_cvt_pk_bf16_f32 v0, v172, v173
    v_mfma_f32_16x16x32_bf16 v[168:171], v[88:91], v[144:147], v[168:171]
    v_cvt_pk_bf16_f32 v1, v174, v175
    v_cvt_pk_bf16_f32 v2, v176, v177
    v_mfma_f32_16x16x32_bf16 v[148:151], v[68:71], v[144:147], v[148:151]
    v_cvt_pk_bf16_f32 v3, v178, v179
    v_cvt_pk_bf16_f32 v4, v180, v181
    v_mfma_f32_16x16x32_bf16 v[152:155], v[76:79], v[144:147], v[152:155]
    v_cvt_pk_bf16_f32 v5, v182, v183
    v_cvt_pk_bf16_f32 v32, v184, v185
    v_mfma_f32_16x16x32_bf16 v[164:167], v[84:87], v[144:147], v[164:167]
    v_cvt_pk_bf16_f32 v33, v186, v187
    v_cvt_pk_bf16_f32 v34, v188, v189
    v_cvt_pk_bf16_f32 v35, v190, v191
    v_cvt_pk_bf16_f32 v36, v192, v193
    s_waitcnt lgkmcnt(2)
    v_mfma_f32_16x16x32_bf16 v[196:199], a[0:3], v[212:215], 0
    ds_read_b128 v[220:223], v247 offset:24704
    ds_read_b128 v[224:227], v248 offset:24704
    v_mfma_f32_16x16x32_bf16 v[172:175], a[24:27], v[212:215], 0
    ds_read_b128 v[228:231], v247 offset:24832
    ds_read_b128 v[232:235], v248 offset:24832
    v_mfma_f32_16x16x32_bf16 v[176:179], a[48:51], v[212:215], 0
    v_cvt_pk_bf16_f32 v37, v194, v195
    v_mfma_f32_16x16x32_bf16 v[180:183], a[72:75], v[212:215], 0
    v_rcp_f32 v160, v160
    v_mfma_f32_16x16x32_bf16 v[184:187], a[96:99], v[212:215], 0
    ds_read_b128 v[124:127], v250 offset:9216
    v_mul_f32 v132, v132, v160
    v_mfma_f32_16x16x32_bf16 v[188:191], a[120:123], v[212:215], 0
    s_waitcnt lgkmcnt(5)
    ds_read_b128 v[212:215], v247 offset:30720
    v_mul_f32 v133, v133, v160
    v_mfma_f32_16x16x32_bf16 v[196:199], a[4:7], v[216:219], v[196:199]
    v_mul_f32 v134, v134, v160
    v_mul_f32 v135, v135, v160
    v_mfma_f32_16x16x32_bf16 v[172:175], a[28:31], v[216:219], v[172:175]
    v_cvt_pk_bf16_f32 v132, v132, v133
    v_mul_f32 v136, v136, v160
    v_mfma_f32_16x16x32_bf16 v[176:179], a[52:55], v[216:219], v[176:179]
    v_mul_f32 v137, v137, v160
    v_mul_f32 v138, v138, v160
    v_mfma_f32_16x16x32_bf16 v[180:183], a[76:79], v[216:219], v[180:183]
    s_waitcnt lgkmcnt(5)
    v_mul_f32 v139, v139, v160
    v_cvt_pk_bf16_f32 v133, v134, v135
    v_mfma_f32_16x16x32_bf16 v[184:187], a[100:103], v[216:219], v[184:187]
    ds_read_b128 v[128:131], v250 offset:10240
    v_cvt_pk_bf16_f32 v134, v136, v137
    v_mfma_f32_16x16x32_bf16 v[188:191], a[124:127], v[216:219], v[188:191]
    ds_read_b128 v[216:219], v248 offset:30720
    v_cvt_pk_bf16_f32 v135, v138, v139
    v_mfma_f32_16x16x32_bf16 v[196:199], a[8:11], v[220:223], v[196:199]
    ds_read_b32 v136, v250 offset:12300
    v_mul_f32 v156, v156, v160
    v_mfma_f32_16x16x32_bf16 v[172:175], a[32:35], v[220:223], v[172:175]
    v_rcp_f32 v168, v168
    v_mfma_f32_16x16x32_bf16 v[176:179], a[56:59], v[220:223], v[176:179]
    v_mul_f32 v148, v148, v168
    v_mul_f32 v149, v149, v168
    v_mfma_f32_16x16x32_bf16 v[180:183], a[80:83], v[220:223], v[180:183]
    s_waitcnt lgkmcnt(7)
    v_mul_f32 v157, v157, v160
    v_mul_f32 v150, v150, v168
    v_mfma_f32_16x16x32_bf16 v[184:187], a[104:107], v[220:223], v[184:187]
    v_mul_f32 v151, v151, v168
    v_mul_f32 v164, v164, v168
    v_mfma_f32_16x16x32_bf16 v[188:191], a[128:131], v[220:223], v[188:191]
    ds_read_b128 v[220:223], v247 offset:30848
    v_mul_f32 v165, v165, v168
    v_mfma_f32_16x16x32_bf16 v[196:199], a[12:15], v[224:227], v[196:199]
    v_cvt_pk_bf16_f32 v148, v148, v149
    v_mul_f32 v158, v158, v160
    v_mfma_f32_16x16x32_bf16 v[172:175], a[36:39], v[224:227], v[172:175]
    v_mul_f32 v159, v159, v160
    v_mul_f32 v152, v152, v168
    v_mfma_f32_16x16x32_bf16 v[176:179], a[60:63], v[224:227], v[176:179]
    v_mul_f32 v153, v153, v168
    v_mul_f32 v154, v154, v168
    v_mfma_f32_16x16x32_bf16 v[180:183], a[84:87], v[224:227], v[180:183]
    s_waitcnt lgkmcnt(7)
    v_mul_f32 v155, v155, v168
    v_mul_f32 v166, v166, v168
    v_mfma_f32_16x16x32_bf16 v[184:187], a[108:111], v[224:227], v[184:187]
    v_mul_f32 v167, v167, v168
    v_cvt_pk_bf16_f32 v156, v156, v157
    v_mfma_f32_16x16x32_bf16 v[188:191], a[132:135], v[224:227], v[188:191]
    ds_read_b128 v[224:227], v248 offset:30848
    v_cvt_pk_bf16_f32 v164, v164, v165
    v_mfma_f32_16x16x32_bf16 v[196:199], a[16:19], v[228:231], v[196:199]
    v_cvt_pk_bf16_f32 v149, v150, v151
    v_cvt_pk_bf16_f32 v157, v158, v159
    v_mfma_f32_16x16x32_bf16 v[172:175], a[40:43], v[228:231], v[172:175]
    v_cvt_pk_bf16_f32 v165, v166, v167
    v_cvt_pk_bf16_f32 v150, v152, v153
    v_mfma_f32_16x16x32_bf16 v[176:179], a[64:67], v[228:231], v[176:179]
    v_cvt_pk_bf16_f32 v151, v154, v155
    v_mfma_f32_16x16x32_bf16 v[180:183], a[88:91], v[228:231], v[180:183]
    s_waitcnt lgkmcnt(7)
    ds_read_b128 v[140:143], v250 offset:0
    ds_read_b128 v[144:147], v250 offset:1024
    v_mfma_f32_16x16x32_bf16 v[184:187], a[112:115], v[228:231], v[184:187]
    ds_read_b32 v152, v250 offset:12288
    v_mfma_f32_16x16x32_bf16 v[188:191], a[136:139], v[228:231], v[188:191]
    ds_read_b128 v[228:231], v247 offset:30976
    v_mfma_f32_16x16x32_bf16 v[196:199], a[20:23], v[232:235], v[196:199]
    s_nop 0
    s_waitcnt lgkmcnt(6)
    v_cndmask_b32 v136, v254, v136, s[58:59]
    v_mfma_f32_16x16x32_bf16 v[172:175], a[44:47], v[232:235], v[172:175]
    s_nop 0
    v_mfma_f32_16x16x32_bf16 v[176:179], a[68:71], v[232:235], v[176:179]
    s_nop 0
    s_nop 0
    v_cvt_pk_bf16_f32 v8, v196, v197
    v_mfma_f32_16x16x32_bf16 v[180:183], a[92:95], v[232:235], v[180:183]
    s_nop 0
    v_cvt_pk_bf16_f32 v9, v198, v199
    v_cvt_pk_bf16_f32 v10, v172, v173
    v_mfma_f32_16x16x32_bf16 v[184:187], a[116:119], v[232:235], v[184:187]
    v_cvt_pk_bf16_f32 v11, v174, v175
    v_cvt_pk_bf16_f32 v12, v176, v177
    v_mfma_f32_16x16x32_bf16 v[188:191], a[140:143], v[232:235], v[188:191]
    v_cvt_pk_bf16_f32 v13, v178, v179
    v_cvt_pk_bf16_f32 v40, v180, v181
    v_mfma_f32_16x16x32_bf16 v[192:195], a[0:3], v[212:215], 0
    s_nop 0
    v_cvt_pk_bf16_f32 v41, v182, v183
    v_cvt_pk_bf16_f32 v42, v184, v185
    v_mfma_f32_16x16x32_bf16 v[196:199], a[24:27], v[212:215], 0
    v_cvt_pk_bf16_f32 v43, v186, v187
    v_cvt_pk_bf16_f32 v44, v188, v189
    v_mfma_f32_16x16x32_bf16 v[172:175], a[48:51], v[212:215], 0
    ds_read_b128 v[232:235], v248 offset:30976
    v_cvt_pk_bf16_f32 v45, v190, v191
    v_mfma_f32_16x16x32_bf16 v[176:179], a[72:75], v[212:215], 0
    s_waitcnt lgkmcnt(2)
    v_cndmask_b32 v152, v254, v152, s[58:59]
    v_mfma_f32_16x16x32_bf16 v[180:183], a[96:99], v[212:215], 0
    v_mfma_f32_16x16x32_bf16 v[184:187], a[120:123], v[212:215], 0
    ds_read_b128 v[212:215], v247 offset:18432
    v_mfma_f32_16x16x32_bf16 v[192:195], a[4:7], v[216:219], v[192:195]
    v_mfma_f32_16x16x32_bf16 v[196:199], a[28:31], v[216:219], v[196:199]
    v_mfma_f32_16x16x32_bf16 v[172:175], a[52:55], v[216:219], v[172:175]
    v_mfma_f32_16x16x32_bf16 v[176:179], a[76:79], v[216:219], v[176:179]
    v_mfma_f32_16x16x32_bf16 v[180:183], a[100:103], v[216:219], v[180:183]
    v_mfma_f32_16x16x32_bf16 v[184:187], a[124:127], v[216:219], v[184:187]
    ds_read_b128 v[216:219], v248 offset:18432
    v_mfma_f32_16x16x32_bf16 v[192:195], a[8:11], v[220:223], v[192:195]
    v_mfma_f32_16x16x32_bf16 v[196:199], a[32:35], v[220:223], v[196:199]
    v_mfma_f32_16x16x32_bf16 v[172:175], a[56:59], v[220:223], v[172:175]
    v_mfma_f32_16x16x32_bf16 v[176:179], a[80:83], v[220:223], v[176:179]
    v_mfma_f32_16x16x32_bf16 v[180:183], a[104:107], v[220:223], v[180:183]
    v_mfma_f32_16x16x32_bf16 v[184:187], a[128:131], v[220:223], v[184:187]
    ds_read_b128 v[220:223], v247 offset:18560
    v_mfma_f32_16x16x32_bf16 v[192:195], a[12:15], v[224:227], v[192:195]
    v_mfma_f32_16x16x32_bf16 v[196:199], a[36:39], v[224:227], v[196:199]
    v_mfma_f32_16x16x32_bf16 v[172:175], a[60:63], v[224:227], v[172:175]
    v_mfma_f32_16x16x32_bf16 v[176:179], a[84:87], v[224:227], v[176:179]
    s_waitcnt lgkmcnt(4)
    v_mfma_f32_16x16x32_bf16 v[180:183], a[108:111], v[224:227], v[180:183]
    v_mfma_f32_16x16x32_bf16 v[184:187], a[132:135], v[224:227], v[184:187]
    ds_read_b128 v[224:227], v248 offset:18560
    v_mfma_f32_16x16x32_bf16 v[192:195], a[16:19], v[228:231], v[192:195]
    v_mfma_f32_16x16x32_bf16 v[196:199], a[40:43], v[228:231], v[196:199]
    v_mfma_f32_16x16x32_bf16 v[172:175], a[64:67], v[228:231], v[172:175]
    v_mfma_f32_16x16x32_bf16 v[176:179], a[88:91], v[228:231], v[176:179]
    s_waitcnt lgkmcnt(4)
    v_mfma_f32_16x16x32_bf16 v[180:183], a[112:115], v[228:231], v[180:183]
    v_mfma_f32_16x16x32_bf16 v[184:187], a[136:139], v[228:231], v[184:187]
    ds_read_b128 v[228:231], v247 offset:18688
    v_mfma_f32_16x16x32_bf16 v[192:195], a[20:23], v[232:235], v[192:195]
    s_nop 0
    v_mfma_f32_16x16x32_bf16 v[196:199], a[44:47], v[232:235], v[196:199]
    s_nop 0
    v_mfma_f32_16x16x32_bf16 v[172:175], a[68:71], v[232:235], v[172:175]
    s_nop 0
    v_mfma_f32_16x16x32_bf16 v[176:179], a[92:95], v[232:235], v[176:179]
    s_waitcnt lgkmcnt(4)
    s_nop 0
    v_cvt_pk_bf16_f32 v16, v192, v193
    v_mfma_f32_16x16x32_bf16 v[180:183], a[116:119], v[232:235], v[180:183]
    v_cvt_pk_bf16_f32 v17, v194, v195
    v_cvt_pk_bf16_f32 v18, v196, v197
    v_mfma_f32_16x16x32_bf16 v[184:187], a[140:143], v[232:235], v[184:187]
    v_cvt_pk_bf16_f32 v19, v198, v199
    v_cvt_pk_bf16_f32 v20, v172, v173
    v_mfma_f32_16x16x32_bf16 v[188:191], v[212:215], a[144:147], 0
    s_waitcnt lgkmcnt(3)
    ds_read_b128 v[232:235], v248 offset:18688
    v_cvt_pk_bf16_f32 v21, v174, v175
    v_mfma_f32_16x16x32_bf16 v[192:195], v[212:215], a[168:171], 0
    buffer_load_dwordx4 v244, s[24:27], s49 offen offset:0 lds
    v_mfma_f32_16x16x32_bf16 v[196:199], v[212:215], a[192:195], 0
    ds_read_b128 v[212:215], v247 offset:24576
    v_cvt_pk_bf16_f32 v48, v176, v177
    v_mfma_f32_16x16x32_bf16 v[188:191], v[216:219], a[148:151], v[188:191]
    s_waitcnt lgkmcnt(4)
    v_cvt_pk_bf16_f32 v49, v178, v179
    v_cvt_pk_bf16_f32 v50, v180, v181
    v_mfma_f32_16x16x32_bf16 v[192:195], v[216:219], a[172:175], v[192:195]
    v_cvt_pk_bf16_f32 v51, v182, v183
    v_cvt_pk_bf16_f32 v52, v184, v185
    v_mfma_f32_16x16x32_bf16 v[196:199], v[216:219], a[196:199], v[196:199]
    ds_write_b128 v251, v[132:135] offset:12288
    buffer_load_dwordx4 v245, s[24:27], s49 offen offset:1024 lds
    buffer_load_dwordx4 v246, s[24:27], s49 offen offset:2048 lds
    v_mfma_f32_16x16x32_bf16 v[188:191], v[220:223], a[152:155], v[188:191]
    s_waitcnt lgkmcnt(4)
    ds_read_b128 v[132:135], v250 offset:11264
    ds_read_b128 v[216:219], v248 offset:24576
    v_mfma_f32_16x16x32_bf16 v[192:195], v[220:223], a[176:179], v[192:195]
    v_cvt_pk_bf16_f32 v53, v186, v187
    v_mfma_f32_16x16x32_bf16 v[196:199], v[220:223], a[200:203], v[196:199]
    ds_read_b128 v[220:223], v247 offset:24704
    v_mfma_f32_16x16x32_bf16 v[188:191], v[224:227], a[156:159], v[188:191]
    s_waitcnt lgkmcnt(6)
    v_mfma_f32_16x16x32_bf16 v[192:195], v[224:227], a[180:183], v[192:195]
    v_mfma_f32_16x16x32_bf16 v[196:199], v[224:227], a[204:207], v[196:199]
    ds_read_b128 v[224:227], v248 offset:24704
    v_mfma_f32_16x16x32_bf16 v[188:191], v[228:231], a[160:163], v[188:191]
    s_waitcnt lgkmcnt(6)
    s_waitcnt vmcnt(3)
    v_mfma_f32_16x16x32_bf16 v[192:195], v[228:231], a[184:187], v[192:195]
    ds_read_b64_tr_b16 a[224:225], v241 offset:24576
    ds_read_b64_tr_b16 a[248:249], v241 offset:24584
    v_mfma_f32_16x16x32_bf16 v[196:199], v[228:231], a[208:211], v[196:199]
    ds_read_b64_tr_b16 v[108:109], v255 offset:24576
    ds_read_b64_tr_b16 a[226:227], v241 offset:26112
    v_mfma_f32_16x16x32_bf16 v[188:191], v[232:235], a[164:167], v[188:191]
    ds_read_b64_tr_b16 a[250:251], v241 offset:26120
    ds_read_b64_tr_b16 v[110:111], v255 offset:26112
    v_mfma_f32_16x16x32_bf16 v[192:195], v[232:235], a[188:191], v[192:195]
    ds_read_b64_tr_b16 a[236:237], v241 offset:36864
    ds_read_b64_tr_b16 v[96:97], v241 offset:36872
    v_mfma_f32_16x16x32_bf16 v[196:199], v[232:235], a[212:215], v[196:199]
    s_waitcnt lgkmcnt(11)
    ds_read_b64_tr_b16 v[120:121], v255 offset:36864
    ds_read_b64_tr_b16 a[228:229], v241 offset:38400
    v_mfma_f32_16x16x32_bf16 v[124:127], v[0:3], v[56:59], v[124:127]
    ds_read_b64_tr_b16 a[252:253], v241 offset:38408
    ds_read_b64_tr_b16 v[112:113], v255 offset:38400
    v_mfma_f32_16x16x32_bf16 v[128:131], v[8:11], v[56:59], v[128:131]
    ds_write_b64 v252, v[156:157] offset:12288
    ds_write_b64 v252, v[164:165] offset:18432
    ds_write_b128 v251, v[148:151] offset:18432
    v_mfma_f32_16x16x32_bf16 v[132:135], v[16:19], v[56:59], v[132:135]
    ds_read_b128 v[148:151], v250 offset:2048
    ds_read_b128 v[228:231], v247 offset:24832
    v_mfma_f32_16x16x32_bf16 v[136:139], v[24:27], v[56:59], v[136:139]
    ds_read_b128 v[232:235], v248 offset:24832
    v_cvt_pk_bf16_f32 v64, v188, v189
    v_mfma_f32_16x16x32_bf16 v[124:127], v[4:7], v[60:63], v[124:127]
    v_cvt_pk_bf16_f32 v65, v190, v191
    v_cvt_pk_bf16_f32 v72, v192, v193
    v_mfma_f32_16x16x32_bf16 v[128:131], v[12:15], v[60:63], v[128:131]
    v_cvt_pk_bf16_f32 v73, v194, v195
    v_cvt_pk_bf16_f32 v80, v196, v197
    v_mfma_f32_16x16x32_bf16 v[132:135], v[20:23], v[60:63], v[132:135]
    v_cvt_pk_bf16_f32 v81, v198, v199
    v_mfma_f32_16x16x32_bf16 v[136:139], v[28:31], v[60:63], v[136:139]
    s_nop 0
    v_mfma_f32_16x16x32_bf16 v[172:175], v[212:215], a[144:147], 0
    s_waitcnt lgkmcnt(14)
    v_mfma_f32_16x16x32_bf16 v[176:179], v[212:215], a[168:171], 0
    s_nop 0
    v_mfma_f32_16x16x32_bf16 v[180:183], v[212:215], a[192:195], 0
    s_nop 0
    ds_read_b128 v[212:215], v247 offset:30720
    v_max3_f32 v137, v124, v125, v126
    v_mfma_f32_16x16x32_bf16 v[172:175], v[216:219], a[148:151], v[172:175]
    v_max3_f32 v138, v127, v128, v129
    v_max3_f32 v137, v137, v130, v131
    v_mfma_f32_16x16x32_bf16 v[176:179], v[216:219], a[172:175], v[176:179]
    v_max3_f32 v138, v138, v132, v133
    v_max3_f32 v137, v137, v134, v135
    v_mfma_f32_16x16x32_bf16 v[180:183], v[216:219], a[196:199], v[180:183]
    ds_read_b128 v[216:219], v248 offset:30720
    v_max3_f32 v137, v137, v138, v136
    v_mfma_f32_16x16x32_bf16 v[172:175], v[220:223], a[152:155], v[172:175]
    v_mov_b32 v138, v137
    v_mfma_f32_16x16x32_bf16 v[176:179], v[220:223], a[176:179], v[176:179]
    s_nop 0
    v_permlane32_swap_b32 v137, v138
    v_mfma_f32_16x16x32_bf16 v[180:183], v[220:223], a[200:203], v[180:183]
    ds_read_b128 v[220:223], v247 offset:30848
    v_max_f32 v137, v137, v138
    v_mfma_f32_16x16x32_bf16 v[140:143], v[0:3], v[32:35], v[140:143]
    v_mov_b32 v138, v137
    v_mfma_f32_16x16x32_bf16 v[144:147], v[8:11], v[32:35], v[144:147]
    s_nop 0
    v_permlane16_swap_b32 v137, v138
    s_waitcnt lgkmcnt(5)
    v_mfma_f32_16x16x32_bf16 v[148:151], v[16:19], v[32:35], v[148:151]
    v_max_f32 v137, v137, v138
    v_mul_f32 v137, s38, v137
    v_mfma_f32_16x16x32_bf16 v[152:155], v[24:27], v[32:35], v[152:155]
    v_fma_f32 v124, v124, s38, -v137
    v_fma_f32 v125, v125, s38, -v137
    v_mfma_f32_16x16x32_bf16 v[140:143], v[4:7], v[36:39], v[140:143]
    v_fma_f32 v126, v126, s38, -v137
    v_fma_f32 v127, v127, s38, -v137
    v_mfma_f32_16x16x32_bf16 v[144:147], v[12:15], v[36:39], v[144:147]
    v_exp_f32 v124, v124
    v_mfma_f32_16x16x32_bf16 v[148:151], v[20:23], v[36:39], v[148:151]
    v_exp_f32 v125, v125
    v_mfma_f32_16x16x32_bf16 v[152:155], v[28:31], v[36:39], v[152:155]
    v_fma_f32 v128, v128, s38, -v137
    v_fma_f32 v129, v129, s38, -v137
    v_mfma_f32_16x16x32_bf16 v[172:175], v[224:227], a[156:159], v[172:175]
    s_waitcnt lgkmcnt(4)
    v_fma_f32 v130, v130, s38, -v137
    v_fma_f32 v131, v131, s38, -v137
    v_mfma_f32_16x16x32_bf16 v[176:179], v[224:227], a[180:183], v[176:179]
    v_exp_f32 v126, v126
    v_mfma_f32_16x16x32_bf16 v[180:183], v[224:227], a[204:207], v[180:183]
    ds_read_b128 v[224:227], v248 offset:30848
    v_cvt_pk_bf16_f32 v124, v124, v125
    v_mfma_f32_16x16x32_bf16 v[172:175], v[228:231], a[160:163], v[172:175]
    s_waitcnt lgkmcnt(4)
    v_exp_f32 v127, v127
    v_mfma_f32_16x16x32_bf16 v[176:179], v[228:231], a[184:187], v[176:179]
    v_exp_f32 v128, v128
    v_mfma_f32_16x16x32_bf16 v[180:183], v[228:231], a[208:211], v[180:183]
    ds_read_b128 v[228:231], v247 offset:30976
    v_cvt_pk_bf16_f32 v125, v126, v127
    v_mfma_f32_16x16x32_bf16 v[172:175], v[232:235], a[164:167], v[172:175]
    s_waitcnt lgkmcnt(4)
    v_exp_f32 v129, v129
    v_mfma_f32_16x16x32_bf16 v[176:179], v[232:235], a[188:191], v[176:179]
    v_exp_f32 v130, v130
    v_mfma_f32_16x16x32_bf16 v[180:183], v[232:235], a[212:215], v[180:183]
    ds_read_b128 v[232:235], v248 offset:30976
    v_cvt_pk_bf16_f32 v126, v128, v129
    v_mfma_f32_16x16x32_bf16 v[184:187], v[212:215], a[144:147], 0
    s_waitcnt lgkmcnt(4)
    v_exp_f32 v131, v131
    v_mfma_f32_16x16x32_bf16 v[188:191], v[212:215], a[168:171], 0
    s_waitcnt vmcnt(0)
    ds_read_b64_tr_b16 a[230:231], v241 offset:49152
    ds_read_b64_tr_b16 a[254:255], v241 offset:49160
    v_mfma_f32_16x16x32_bf16 v[192:195], v[212:215], a[192:195], 0
    ds_read_b64_tr_b16 v[114:115], v255 offset:49152
    ds_read_b64_tr_b16 a[238:239], v241 offset:50688
    v_mfma_f32_16x16x32_bf16 v[184:187], v[216:219], a[148:151], v[184:187]
    s_waitcnt lgkmcnt(7)
    ds_read_b64_tr_b16 v[98:99], v241 offset:50696
    ds_read_b64_tr_b16 v[122:123], v255 offset:50688
    v_mfma_f32_16x16x32_bf16 v[188:191], v[216:219], a[172:175], v[188:191]
    v_cvt_pk_bf16_f32 v127, v130, v131
    v_fma_f32 v132, v132, s38, -v137
    v_mfma_f32_16x16x32_bf16 v[192:195], v[216:219], a[196:199], v[192:195]
    v_fma_f32 v133, v133, s38, -v137
    v_fma_f32 v134, v134, s38, -v137
    v_mfma_f32_16x16x32_bf16 v[184:187], v[220:223], a[152:155], v[184:187]
    s_waitcnt lgkmcnt(8)
    v_fma_f32 v135, v135, s38, -v137
    v_cvt_pk_bf16_f32 v66, v172, v173
    v_mfma_f32_16x16x32_bf16 v[188:191], v[220:223], a[176:179], v[188:191]
    v_exp_f32 v132, v132
    v_mfma_f32_16x16x32_bf16 v[192:195], v[220:223], a[200:203], v[192:195]
    v_exp_f32 v133, v133
    v_mfma_f32_16x16x32_bf16 v[184:187], v[224:227], a[156:159], v[184:187]
    s_waitcnt lgkmcnt(7)
    v_exp_f32 v134, v134
    v_mfma_f32_16x16x32_bf16 v[188:191], v[224:227], a[180:183], v[188:191]
    v_exp_f32 v135, v135
    v_mfma_f32_16x16x32_bf16 v[192:195], v[224:227], a[204:207], v[192:195]
    v_cvt_pk_bf16_f32 v67, v174, v175
    v_fma_f32 v136, v136, s38, -v137
    v_mfma_f32_16x16x32_bf16 v[184:187], v[228:231], a[160:163], v[184:187]
    s_waitcnt lgkmcnt(6)
    v_cvt_pk_bf16_f32 v128, v132, v133
    v_cvt_pk_bf16_f32 v129, v134, v135
    v_mfma_f32_16x16x32_bf16 v[188:191], v[228:231], a[184:187], v[188:191]
    v_max3_f32 v153, v140, v141, v142
    v_max3_f32 v154, v143, v144, v145
    v_mfma_f32_16x16x32_bf16 v[192:195], v[228:231], a[208:211], v[192:195]
    v_exp_f32 v136, v136
    v_mfma_f32_16x16x32_bf16 v[184:187], v[232:235], a[164:167], v[184:187]
    v_cvt_pk_bf16_f32 v74, v176, v177
    v_cvt_pk_bf16_f32 v75, v178, v179
    v_mfma_f32_16x16x32_bf16 v[188:191], v[232:235], a[188:191], v[188:191]
    v_max3_f32 v153, v153, v146, v147
    v_max3_f32 v154, v154, v148, v149
    v_mfma_f32_16x16x32_bf16 v[192:195], v[232:235], a[212:215], v[192:195]
    v_max3_f32 v153, v153, v150, v151
    v_cvt_pk_bf16_f32 v130, v136, 0
    v_mfma_f32_16x16x32_bf16 v[160:163], v[88:91], v[124:127], 0
    v_max3_f32 v153, v153, v154, v152
    v_mov_b32 v154, v153
    v_mfma_f32_16x16x32_bf16 v[132:135], v[64:67], v[124:127], 0
    v_cvt_pk_bf16_f32 v82, v180, v181
    v_cvt_pk_bf16_f32 v83, v182, v183
    v_mfma_f32_16x16x32_bf16 v[136:139], v[72:75], v[124:127], 0
    v_permlane32_swap_b32 v153, v154
    v_mfma_f32_16x16x32_bf16 v[156:159], v[80:83], v[124:127], 0
    s_waitcnt lgkmcnt(0)
    v_mov_b32 v131, 0
    v_max_f32 v153, v153, v154
    v_mov_b32 v154, v153
    v_mfma_f32_16x16x32_bf16 v[160:163], v[88:91], v[128:131], v[160:163]
    s_barrier
    v_cvt_pk_bf16_f32 v68, v184, v185
    v_cvt_pk_bf16_f32 v69, v186, v187
    v_permlane16_swap_b32 v153, v154
    s_mov_b32 m0, s88
    v_mfma_f32_16x16x32_bf16 v[132:135], v[68:71], v[128:131], v[132:135]
    v_cvt_pk_bf16_f32 v76, v188, v189
    v_cvt_pk_bf16_f32 v77, v190, v191
    v_max_f32 v153, v153, v154
    v_mul_f32 v153, s38, v153
    v_mfma_f32_16x16x32_bf16 v[136:139], v[76:79], v[128:131], v[136:139]
    v_fma_f32 v140, v140, s38, -v153
    v_fma_f32 v141, v141, s38, -v153
    v_fma_f32 v142, v142, s38, -v153
    v_fma_f32 v143, v143, s38, -v153
    v_exp_f32 v140, v140
    v_exp_f32 v141, v141
    v_cvt_pk_bf16_f32 v84, v192, v193
    v_cvt_pk_bf16_f32 v85, v194, v195
    v_fma_f32 v144, v144, s38, -v153
    v_fma_f32 v145, v145, s38, -v153
    v_mfma_f32_16x16x32_bf16 v[156:159], v[84:87], v[128:131], v[156:159]
    v_fma_f32 v146, v146, s38, -v153
    v_fma_f32 v147, v147, s38, -v153
    v_exp_f32 v142, v142
    v_exp_f32 v143, v143
    v_exp_f32 v144, v144
    v_exp_f32 v145, v145
    v_exp_f32 v146, v146
    v_exp_f32 v147, v147
    v_cvt_pk_bf16_f32 v140, v140, v141
    v_cvt_pk_bf16_f32 v141, v142, v143
    v_cvt_pk_bf16_f32 v142, v144, v145
    v_cvt_pk_bf16_f32 v143, v146, v147
    v_fma_f32 v148, v148, s38, -v153
    v_fma_f32 v149, v149, s38, -v153
    v_mfma_f32_16x16x32_bf16 v[168:171], v[88:91], v[140:143], 0
    v_fma_f32 v150, v150, s38, -v153
    v_fma_f32 v151, v151, s38, -v153
    v_mfma_f32_16x16x32_bf16 v[164:167], v[80:83], v[140:143], 0
    ds_read_b128 v[212:215], v247 offset:0
    v_exp_f32 v148, v148
    v_exp_f32 v149, v149
    v_exp_f32 v150, v150
    v_exp_f32 v151, v151
    v_fma_f32 v152, v152, s38, -v153
    v_cvt_pk_bf16_f32 v144, v148, v149
    v_cvt_pk_bf16_f32 v145, v150, v151
    v_mfma_f32_16x16x32_bf16 v[148:151], v[64:67], v[140:143], 0
    v_exp_f32 v152, v152
    v_mov_b32 v147, 0
    v_cvt_pk_bf16_f32 v146, v152, 0
    v_mfma_f32_16x16x32_bf16 v[152:155], v[72:75], v[140:143], 0
    ds_read_b128 v[216:219], v248 offset:0
    ds_read_b128 v[220:223], v247 offset:128
    v_mfma_f32_16x16x32_bf16 v[168:171], v[88:91], v[144:147], v[168:171]
    v_rcp_f32 v160, v160
    v_mfma_f32_16x16x32_bf16 v[148:151], v[68:71], v[144:147], v[148:151]
    ds_read_b128 v[124:127], v250 offset:3072
    v_mul_f32 v132, v132, v160
    v_mfma_f32_16x16x32_bf16 v[152:155], v[76:79], v[144:147], v[152:155]
    s_waitcnt lgkmcnt(3)
    v_mul_f32 v133, v133, v160
    v_mfma_f32_16x16x32_bf16 v[164:167], v[84:87], v[144:147], v[164:167]
    v_mul_f32 v134, v134, v160
    v_mul_f32 v135, v135, v160
    v_mfma_f32_16x16x32_bf16 v[196:199], a[0:3], v[212:215], 0
    v_cvt_pk_bf16_f32 v132, v132, v133
    v_mul_f32 v136, v136, v160
    v_mfma_f32_16x16x32_bf16 v[172:175], a[24:27], v[212:215], 0
    v_mul_f32 v137, v137, v160
    v_mul_f32 v138, v138, v160
    v_mfma_f32_16x16x32_bf16 v[176:179], a[48:51], v[212:215], 0
    v_mul_f32 v139, v139, v160
    v_cvt_pk_bf16_f32 v133, v134, v135
    v_mfma_f32_16x16x32_bf16 v[180:183], a[72:75], v[212:215], 0
    s_waitcnt lgkmcnt(2)
    ds_read_b128 v[128:131], v250 offset:4096
    v_mfma_f32_16x16x32_bf16 v[184:187], a[96:99], v[212:215], 0
    v_cvt_pk_bf16_f32 v134, v136, v137
    v_cvt_pk_bf16_f32 v135, v138, v139
    v_mfma_f32_16x16x32_bf16 v[188:191], a[120:123], v[212:215], 0
    s_mov_b64 exec, s[66:67]
    ds_write_b128 v251, v[132:135] offset:0
    s_mov_b64 exec, -1
    v_mfma_f32_16x16x32_bf16 v[196:199], a[4:7], v[216:219], v[196:199]
    ds_read_b128 v[132:135], v250 offset:5120
    ds_read_b32 v136, v250 offset:12292
    v_mfma_f32_16x16x32_bf16 v[172:175], a[28:31], v[216:219], v[172:175]
    ds_read_b128 v[224:227], v248 offset:128
    ds_read_b128 v[228:231], v247 offset:256
    v_mfma_f32_16x16x32_bf16 v[176:179], a[52:55], v[216:219], v[176:179]
    ds_read_b128 v[232:235], v248 offset:256
    ds_read_b128 v[140:143], v250 offset:6144
    v_mfma_f32_16x16x32_bf16 v[180:183], a[76:79], v[216:219], v[180:183]
    s_waitcnt lgkmcnt(9)
    v_rcp_f32 v168, v168
    v_mfma_f32_16x16x32_bf16 v[184:187], a[100:103], v[216:219], v[184:187]
    v_mul_f32 v148, v148, v168
    v_mul_f32 v149, v149, v168
    v_mfma_f32_16x16x32_bf16 v[188:191], a[124:127], v[216:219], v[188:191]
    v_mul_f32 v150, v150, v168
    v_mul_f32 v151, v151, v168
    v_mfma_f32_16x16x32_bf16 v[196:199], a[8:11], v[220:223], v[196:199]
    v_cvt_pk_bf16_f32 v148, v148, v149
    v_mul_f32 v152, v152, v168
    v_mfma_f32_16x16x32_bf16 v[172:175], a[32:35], v[220:223], v[172:175]
    v_mul_f32 v153, v153, v168
    v_mul_f32 v154, v154, v168
    v_mfma_f32_16x16x32_bf16 v[176:179], a[56:59], v[220:223], v[176:179]
    v_mul_f32 v155, v155, v168
    v_cvt_pk_bf16_f32 v149, v150, v151
    v_mfma_f32_16x16x32_bf16 v[180:183], a[80:83], v[220:223], v[180:183]
    s_waitcnt lgkmcnt(8)
    ds_read_b128 v[144:147], v250 offset:7168
    v_cvt_pk_bf16_f32 v150, v152, v153
    v_mfma_f32_16x16x32_bf16 v[184:187], a[104:107], v[220:223], v[184:187]
    s_waitcnt lgkmcnt(8)
    v_cvt_pk_bf16_f32 v151, v154, v155
    v_bfe_u32 v255, v253, 0, 1
    v_mfma_f32_16x16x32_bf16 v[188:191], a[128:131], v[220:223], v[188:191]
    s_waitcnt lgkmcnt(5)
    v_cndmask_b32 v136, v254, v136, s[58:59]
    v_mul_u32_u24 v255, s74, v255
    v_mfma_f32_16x16x32_bf16 v[124:127], v[0:3], v[40:43], v[124:127]
    ds_read_b32 v152, v250 offset:12296
    ds_read_b128 v[212:215], v247 offset:6144
    v_mfma_f32_16x16x32_bf16 v[128:131], v[8:11], v[40:43], v[128:131]
    ds_read_b128 v[216:219], v248 offset:6144
    ds_read_b128 v[220:223], v247 offset:6272
    v_mfma_f32_16x16x32_bf16 v[132:135], v[16:19], v[40:43], v[132:135]
    v_sub_u32 v255, 8064, v255
    v_add_u32 v236, v236, v255
    v_mfma_f32_16x16x32_bf16 v[136:139], v[24:27], v[40:43], v[136:139]
    v_bfe_u32 v255, v253, 1, 1
    v_mul_u32_u24 v255, s74, v255
    v_mfma_f32_16x16x32_bf16 v[124:127], v[4:7], v[44:47], v[124:127]
    v_sub_u32 v255, 8064, v255
    v_add_u32 v237, v237, v255
    v_mfma_f32_16x16x32_bf16 v[128:131], v[12:15], v[44:47], v[128:131]
    s_waitcnt lgkmcnt(8)
    v_bfe_u32 v255, v253, 2, 1
    v_mul_u32_u24 v255, s74, v255
    v_mfma_f32_16x16x32_bf16 v[132:135], v[20:23], v[44:47], v[132:135]
L_pad3:
    s_cbranch_execz L_ret3
    v_sub_u32 v255, 8064, v255
    v_add_u32 v238, v238, v255
    v_mfma_f32_16x16x32_bf16 v[136:139], v[28:31], v[44:47], v[136:139]
    v_bfe_u32 v255, v253, 3, 1
    v_mul_u32_u24 v255, s74, v255
    v_mfma_f32_16x16x32_bf16 v[196:199], a[12:15], v[224:227], v[196:199]
    v_sub_u32 v255, 8064, v255
    v_add_u32 v239, v239, v255
    v_mfma_f32_16x16x32_bf16 v[172:175], a[36:39], v[224:227], v[172:175]
    v_bfe_u32 v255, v253, 4, 1
    v_mul_u32_u24 v255, s74, v255
    v_mfma_f32_16x16x32_bf16 v[176:179], a[60:63], v[224:227], v[176:179]
    v_sub_u32 v255, 8064, v255
    v_add_u32 v240, v240, v255
    v_mfma_f32_16x16x32_bf16 v[180:183], a[84:87], v[224:227], v[180:183]
    s_waitcnt lgkmcnt(7)
    v_mul_f32 v156, v156, v160
    v_mul_f32 v157, v157, v160
    v_mfma_f32_16x16x32_bf16 v[184:187], a[108:111], v[224:227], v[184:187]
    v_mul_f32 v164, v164, v168
    v_mul_f32 v165, v165, v168
    v_mfma_f32_16x16x32_bf16 v[188:191], a[132:135], v[224:227], v[188:191]
    ds_write_b128 v251, v[148:151] offset:24576
    v_mfma_f32_16x16x32_bf16 v[196:199], a[16:19], v[228:231], v[196:199]
    ds_read_b128 v[148:151], v250 offset:8192
    ds_read_b128 v[224:227], v248 offset:6272
    v_mfma_f32_16x16x32_bf16 v[172:175], a[40:43], v[228:231], v[172:175]
    v_mul_f32 v158, v158, v160
    v_mul_f32 v159, v159, v160
    v_mfma_f32_16x16x32_bf16 v[176:179], a[64:67], v[228:231], v[176:179]
    v_mul_f32 v166, v166, v168
    v_mul_f32 v167, v167, v168
    v_mfma_f32_16x16x32_bf16 v[180:183], a[88:91], v[228:231], v[180:183]
    s_waitcnt lgkmcnt(9)
    v_cvt_pk_bf16_f32 v156, v156, v157
    v_cvt_pk_bf16_f32 v164, v164, v165
    v_mfma_f32_16x16x32_bf16 v[184:187], a[112:115], v[228:231], v[184:187]
    v_cvt_pk_bf16_f32 v157, v158, v159
    v_cvt_pk_bf16_f32 v165, v166, v167
    v_mfma_f32_16x16x32_bf16 v[188:191], a[136:139], v[228:231], v[188:191]
    ds_read_b128 v[228:231], v247 offset:6400
    v_max3_f32 v137, v124, v125, v126
    v_mfma_f32_16x16x32_bf16 v[196:199], a[20:23], v[232:235], v[196:199]
    v_max3_f32 v138, v127, v128, v129
    v_max3_f32 v137, v137, v130, v131
    v_mfma_f32_16x16x32_bf16 v[172:175], a[44:47], v[232:235], v[172:175]
    v_max3_f32 v138, v138, v132, v133
    v_max3_f32 v137, v137, v134, v135
    v_mfma_f32_16x16x32_bf16 v[176:179], a[68:71], v[232:235], v[176:179]
    v_max3_f32 v137, v137, v138, v136
    v_mov_b32 v138, v137
    v_mfma_f32_16x16x32_bf16 v[180:183], a[92:95], v[232:235], v[180:183]
    s_waitcnt lgkmcnt(9)
    s_waitcnt lgkmcnt(7)
    v_cndmask_b32 v152, v254, v152, s[58:59]
    v_mfma_f32_16x16x32_bf16 v[184:187], a[116:119], v[232:235], v[184:187]
    v_permlane32_swap_b32 v137, v138
    s_nop 0
    v_mfma_f32_16x16x32_bf16 v[188:191], a[140:143], v[232:235], v[188:191]
    s_waitcnt lgkmcnt(2)
    v_cvt_pk_bf16_f32 v32, v180, v181
    v_cvt_pk_bf16_f32 v33, v182, v183
    v_mfma_f32_16x16x32_bf16 v[140:143], v[0:3], v[48:51], v[140:143]
    v_cvt_pk_bf16_f32 v0, v196, v197
    v_cvt_pk_bf16_f32 v1, v198, v199
    v_mfma_f32_16x16x32_bf16 v[144:147], v[8:11], v[48:51], v[144:147]
    v_cvt_pk_bf16_f32 v2, v172, v173
    v_cvt_pk_bf16_f32 v3, v174, v175
    v_mfma_f32_16x16x32_bf16 v[148:151], v[16:19], v[48:51], v[148:151]
    v_cvt_pk_bf16_f32 v34, v184, v185
    v_cvt_pk_bf16_f32 v35, v186, v187
    v_mfma_f32_16x16x32_bf16 v[152:155], v[24:27], v[48:51], v[152:155]
    ds_read_b128 v[232:235], v248 offset:6400
    v_cvt_pk_bf16_f32 v36, v188, v189
    v_mfma_f32_16x16x32_bf16 v[140:143], v[4:7], v[52:55], v[140:143]
    v_cvt_pk_bf16_f32 v4, v176, v177
    v_cvt_pk_bf16_f32 v5, v178, v179
    v_mfma_f32_16x16x32_bf16 v[144:147], v[12:15], v[52:55], v[144:147]
    v_cvt_pk_bf16_f32 v37, v190, v191
    v_max_f32 v137, v137, v138
    v_mfma_f32_16x16x32_bf16 v[148:151], v[20:23], v[52:55], v[148:151]
    v_mov_b32 v138, v137
    v_mfma_f32_16x16x32_bf16 v[152:155], v[28:31], v[52:55], v[152:155]
    s_nop 0
    v_permlane16_swap_b32 v137, v138
    v_mfma_f32_16x16x32_bf16 v[192:195], a[0:3], v[212:215], 0
    v_max_f32 v137, v137, v138
    v_mul_f32 v137, s38, v137
    v_mfma_f32_16x16x32_bf16 v[196:199], a[24:27], v[212:215], 0
    v_fma_f32 v124, v124, s38, -v137
    v_fma_f32 v125, v125, s38, -v137
    v_mfma_f32_16x16x32_bf16 v[172:175], a[48:51], v[212:215], 0
    v_fma_f32 v126, v126, s38, -v137
    v_fma_f32 v127, v127, s38, -v137
    v_mfma_f32_16x16x32_bf16 v[176:179], a[72:75], v[212:215], 0
    v_exp_f32 v124, v124
    v_mfma_f32_16x16x32_bf16 v[180:183], a[96:99], v[212:215], 0
    v_exp_f32 v125, v125
    v_mfma_f32_16x16x32_bf16 v[184:187], a[120:123], v[212:215], 0
    ds_read_b128 v[212:215], v247 offset:12288
    v_fma_f32 v128, v128, s38, -v137
    v_mfma_f32_16x16x32_bf16 v[192:195], a[4:7], v[216:219], v[192:195]
    buffer_load_dwordx4 v236, s[16:19], 0 offen nt lds
    s_add_u32 m0, m0, s89
    v_mfma_f32_16x16x32_bf16 v[196:199], a[28:31], v[216:219], v[196:199]
    buffer_load_dwordx4 v237, s[16:19], 0 offen nt lds
    s_add_u32 m0, m0, s89
    v_mfma_f32_16x16x32_bf16 v[172:175], a[52:55], v[216:219], v[172:175]
    v_fma_f32 v129, v129, s38, -v137
    v_fma_f32 v130, v130, s38, -v137
    v_mfma_f32_16x16x32_bf16 v[176:179], a[76:79], v[216:219], v[176:179]
    v_fma_f32 v131, v131, s38, -v137
    v_cvt_pk_bf16_f32 v124, v124, v125
    v_mfma_f32_16x16x32_bf16 v[180:183], a[100:103], v[216:219], v[180:183]
    buffer_load_dwordx4 v238, s[16:19], 0 offen nt lds
    s_add_u32 m0, m0, s89
    v_mfma_f32_16x16x32_bf16 v[184:187], a[124:127], v[216:219], v[184:187]
    v_mbcnt_lo_u32_b32 v238, -1, 0
    v_mbcnt_hi_u32_b32 v238, -1, v238
    v_mfma_f32_16x16x32_bf16 v[192:195], a[8:11], v[220:223], v[192:195]
    v_and_b32 v237, 15, v238
    v_lshrrev_b32 v236, 4, v238
    v_mfma_f32_16x16x32_bf16 v[196:199], a[32:35], v[220:223], v[196:199]
    v_add_u32 v238, 0, v237
    v_fma_f32 v132, v132, s38, -v137
    v_mfma_f32_16x16x32_bf16 v[172:175], a[56:59], v[220:223], v[172:175]
    buffer_load_dwordx4 v239, s[16:19], 0 offen nt lds
    s_add_u32 m0, m0, s89
    v_mfma_f32_16x16x32_bf16 v[176:179], a[80:83], v[220:223], v[176:179]
    s_waitcnt lgkmcnt(3)
    v_mul_u32_u24 v239, 37, v238
    v_lshrrev_b32 v239, 8, v239
    v_mfma_f32_16x16x32_bf16 v[180:183], a[104:107], v[220:223], v[180:183]
    ds_read_b128 v[216:219], v248 offset:12288
    v_fma_f32 v133, v133, s38, -v137
    v_mfma_f32_16x16x32_bf16 v[184:187], a[128:131], v[220:223], v[184:187]
    s_mov_b64 exec, s[54:55]
    buffer_load_dwordx4 v240, s[16:19], 0 offen nt lds
    s_mov_b64 exec, -1
    v_mfma_f32_16x16x32_bf16 v[192:195], a[12:15], v[224:227], v[192:195]
    v_mov_b32 v240, s40
    v_mad_u32_u24 v241, v238, s79, v240
    v_mfma_f32_16x16x32_bf16 v[196:199], a[36:39], v[224:227], v[196:199]
    v_mad_u32_u24 v241, v239, s80, v241
    v_add_u32 v238, 16, v237
    v_mfma_f32_16x16x32_bf16 v[172:175], a[60:63], v[224:227], v[172:175]
    v_mul_u32_u24 v239, 37, v238
    v_mad_u32_u24 v242, v238, s79, v240
    v_mfma_f32_16x16x32_bf16 v[176:179], a[84:87], v[224:227], v[176:179]
    s_waitcnt lgkmcnt(3)
    v_lshrrev_b32 v239, 8, v239
    v_subrev_u32 v255, 0x1260000, v241
    v_mfma_f32_16x16x32_bf16 v[180:183], a[108:111], v[224:227], v[180:183]
    v_add_u32 v238, 32, v237
    v_mad_u32_u24 v242, v239, s80, v242
    v_mfma_f32_16x16x32_bf16 v[184:187], a[132:135], v[224:227], v[184:187]
    v_min_u32 v241, v241, v255
    v_mul_u32_u24 v239, 37, v238
    v_mfma_f32_16x16x32_bf16 v[192:195], a[16:19], v[228:231], v[192:195]
    v_mad_u32_u24 v243, v238, s79, v240
    v_subrev_u32 v255, 0x1260000, v242
    v_mfma_f32_16x16x32_bf16 v[196:199], a[40:43], v[228:231], v[196:199]
    v_lshrrev_b32 v239, 8, v239
    v_min_u32 v242, v242, v255
    v_mfma_f32_16x16x32_bf16 v[172:175], a[64:67], v[228:231], v[172:175]
    v_mad_u32_u24 v243, v239, s80, v243
    v_subrev_u32 v255, 0x1260000, v243
    v_mfma_f32_16x16x32_bf16 v[176:179], a[88:91], v[228:231], v[176:179]
    s_waitcnt lgkmcnt(2)
    v_min_u32 v243, v243, v255
    v_lshrrev_b32 v255, 1, v236
    v_mfma_f32_16x16x32_bf16 v[180:183], a[112:115], v[228:231], v[180:183]
    v_and_b32 v239, 7, v237
    v_add_u32 v255, s78, v255
    v_mfma_f32_16x16x32_bf16 v[184:187], a[136:139], v[228:231], v[184:187]
    s_mov_b32 s78, 0x38703870
    v_xor_b32 v255, v255, v239
    v_mfma_f32_16x16x32_bf16 v[192:195], a[20:23], v[232:235], v[192:195]
    v_lshlrev_b32 v255, 4, v255
    v_lshl_add_u32 v246, v237, 7, v255
    v_mfma_f32_16x16x32_bf16 v[196:199], a[44:47], v[232:235], v[196:199]
    v_lshl_add_u32 v237, v236, 4, v237
    v_lshrrev_b32 v238, 3, v237
    v_mfma_f32_16x16x32_bf16 v[172:175], a[68:71], v[232:235], v[172:175]
    v_add_u32 v238, s81, v238
    v_mul_u32_u24 v239, 37, v238
    v_mfma_f32_16x16x32_bf16 v[176:179], a[92:95], v[232:235], v[176:179]
    s_mov_b32 s81, 0xe1c0e1c
    v_and_b32 v255, 1, v236
    v_mfma_f32_16x16x32_bf16 v[180:183], a[116:119], v[232:235], v[180:183]
    s_waitcnt lgkmcnt(1)
    v_mad_u32_u24 v244, v238, s79, v240
    v_lshrrev_b32 v239, 8, v239
    v_mfma_f32_16x16x32_bf16 v[184:187], a[140:143], v[232:235], v[184:187]
    s_mov_b64 exec, s[66:67]
    ds_write_b64 v252, v[156:157] offset:0
    s_mov_b64 exec, -1
    ds_write_b64 v252, v[164:165] offset:24576
    v_mfma_f32_16x16x32_bf16 v[188:191], a[0:3], v[212:215], 0
    v_lshl_add_u32 v246, v255, 3, v246
    s_waitcnt lgkmcnt(2)
    v_mfma_f32_16x16x32_bf16 v[188:191], a[4:7], v[216:219], v[188:191]
    v_mad_u32_u24 v244, v239, s80, v244
    v_subrev_u32 v255, 0x1260000, v244
    v_min_u32 v244, v244, v255
    v_mad_i32_i24 v255, v239, s85, v238
    v_add_u32 v238, 8, v238
    v_add_u32 v255, 4, v255
    v_mul_u32_u24 v239, 37, v238
    v_mad_u32_u24 v245, v238, s79, v240
    v_lshrrev_b32 v255, 3, v255
    v_lshrrev_b32 v239, 8, v239
    v_lshl_or_b32 v253, v255, 5, v253
    v_mad_u32_u24 v245, v239, s80, v245
    v_subrev_u32 v255, 0x1260000, v245
    v_min_u32 v245, v245, v255
    v_mad_i32_i24 v255, v239, s85, v238
    v_add_u32 v255, 4, v255
    v_lshrrev_b32 v255, 3, v255
    v_lshl_add_u32 v241, v236, 4, v241
    v_lshl_add_u32 v242, v236, 4, v242
    v_lshl_add_u32 v243, v236, 4, v243
    v_subrev_u32 v238, 8, v238
    v_lshl_or_b32 v253, v255, 6, v253
    v_and_b32 v236, 7, v237
    v_and_b32 v255, 7, v238
    v_xor_b32 v255, v255, v236
    v_lshlrev_b32 v255, 4, v255
    v_lshl_add_u32 v244, v236, 4, v244
    v_lshl_add_u32 v245, v236, 4, v245
    v_lshl_add_u32 v255, v238, 7, v255
    v_add_u32 v246, 0x23200, v246
    v_add_u32 v241, s82, v241
    v_add_u32 v242, s82, v242
    v_add_u32 v243, s82, v243
    v_add_u32 v244, 256, v244
    v_add_u32 v245, 256, v245
    v_add_u32 v236, 0x23200, v255
    v_cvt_pk_bf16_f32 v8, v192, v193
    v_cvt_pk_bf16_f32 v9, v194, v195
    v_mfma_f32_16x16x32_bf16 v[192:195], a[24:27], v[212:215], 0
    s_mov_b32 s79, 0x38703870
    v_cvt_pk_bf16_f32 v10, v196, v197
    v_mfma_f32_16x16x32_bf16 v[192:195], a[28:31], v[216:219], v[192:195]
    s_mov_b32 s80, 0xe1c0e1c
    v_cvt_pk_bf16_f32 v11, v198, v199
    v_mfma_f32_16x16x32_bf16 v[196:199], a[48:51], v[212:215], 0
    s_mov_b32 s85, 0xc387c387
    v_cvt_pk_bf16_f32 v12, v172, v173
    v_mfma_f32_16x16x32_bf16 v[196:199], a[52:55], v[216:219], v[196:199]
    s_lshl_b32 s82, s36, 6
    v_cvt_pk_bf16_f32 v13, v174, v175
    v_cvt_pk_bf16_f32 v40, v176, v177
    v_mfma_f32_16x16x32_bf16 v[172:175], a[72:75], v[212:215], 0
    v_cvt_pk_bf16_f32 v41, v178, v179
    v_cvt_pk_bf16_f32 v42, v180, v181
    v_mfma_f32_16x16x32_bf16 v[176:179], a[96:99], v[212:215], 0
    ds_read_b128 v[220:223], v247 offset:12416
    v_cvt_pk_bf16_f32 v43, v182, v183
    v_mfma_f32_16x16x32_bf16 v[180:183], a[120:123], v[212:215], 0
    ds_read_b128 v[224:227], v248 offset:12416
    ds_read_b128 v[228:231], v247 offset:12544
    v_mfma_f32_16x16x32_bf16 v[172:175], a[76:79], v[216:219], v[172:175]
    ds_read_b128 v[232:235], v248 offset:12544
    v_fma_f32 v134, v134, s38, -v137
    v_mfma_f32_16x16x32_bf16 v[176:179], a[100:103], v[216:219], v[176:179]
    v_exp_f32 v126, v126
    v_mfma_f32_16x16x32_bf16 v[180:183], a[124:127], v[216:219], v[180:183]
    v_exp_f32 v127, v127
    v_exp_f32 v128, v128
    v_exp_f32 v129, v129
    v_exp_f32 v130, v130
    v_exp_f32 v131, v131
    v_cvt_pk_bf16_f32 v125, v126, v127
    v_cvt_pk_bf16_f32 v126, v128, v129
    v_cvt_pk_bf16_f32 v127, v130, v131
    v_fma_f32 v135, v135, s38, -v137
    v_fma_f32 v136, v136, s38, -v137
    v_mfma_f32_16x16x32_bf16 v[160:163], v[88:91], v[124:127], 0
    s_waitcnt lgkmcnt(3)
    v_exp_f32 v132, v132
    v_mfma_f32_16x16x32_bf16 v[188:191], a[8:11], v[220:223], v[188:191]
    v_exp_f32 v133, v133
    v_mfma_f32_16x16x32_bf16 v[192:195], a[32:35], v[220:223], v[192:195]
    ds_read_b128 v[212:215], v247 offset:0
    v_cvt_pk_bf16_f32 v128, v132, v133
    v_mfma_f32_16x16x32_bf16 v[196:199], a[56:59], v[220:223], v[196:199]
    v_exp_f32 v134, v134
    v_mfma_f32_16x16x32_bf16 v[172:175], a[80:83], v[220:223], v[172:175]
    s_waitcnt lgkmcnt(3)
    v_exp_f32 v135, v135
    v_mfma_f32_16x16x32_bf16 v[176:179], a[104:107], v[220:223], v[176:179]
    v_cvt_pk_bf16_f32 v129, v134, v135
    v_mov_b32 v131, 0
    v_mfma_f32_16x16x32_bf16 v[180:183], a[128:131], v[220:223], v[180:183]
    v_exp_f32 v136, v136
    v_mfma_f32_16x16x32_bf16 v[188:191], a[12:15], v[224:227], v[188:191]
    v_cvt_pk_bf16_f32 v130, v136, 0
    v_cvt_pk_bf16_f32 v44, v184, v185
    v_mfma_f32_16x16x32_bf16 v[192:195], a[36:39], v[224:227], v[192:195]
    ds_read_b128 v[216:219], v248 offset:0
    ds_read_b128 v[220:223], v247 offset:128
    v_mfma_f32_16x16x32_bf16 v[196:199], a[60:63], v[224:227], v[196:199]
    v_cvt_pk_bf16_f32 v45, v186, v187
    v_max3_f32 v153, v140, v141, v142
    v_mfma_f32_16x16x32_bf16 v[172:175], a[84:87], v[224:227], v[172:175]
    s_waitcnt lgkmcnt(4)
    v_max3_f32 v154, v143, v144, v145
    v_max3_f32 v153, v153, v146, v147
    v_mfma_f32_16x16x32_bf16 v[176:179], a[108:111], v[224:227], v[176:179]
    v_max3_f32 v154, v154, v148, v149
    v_max3_f32 v153, v153, v150, v151
    v_mfma_f32_16x16x32_bf16 v[180:183], a[132:135], v[224:227], v[180:183]
    v_max3_f32 v153, v153, v154, v152
    v_mov_b32 v154, v153
    v_mfma_f32_16x16x32_bf16 v[188:191], a[16:19], v[228:231], v[188:191]
    s_nop 0
    v_permlane32_swap_b32 v153, v154
    v_mfma_f32_16x16x32_bf16 v[192:195], a[40:43], v[228:231], v[192:195]
    v_max_f32 v153, v153, v154
    v_mov_b32 v154, v153
    v_mfma_f32_16x16x32_bf16 v[196:199], a[64:67], v[228:231], v[196:199]
    s_nop 0
    v_permlane16_swap_b32 v153, v154
    v_mfma_f32_16x16x32_bf16 v[172:175], a[88:91], v[228:231], v[172:175]
    s_waitcnt lgkmcnt(3)
    v_max_f32 v153, v153, v154
    v_mul_f32 v153, s38, v153
    v_mfma_f32_16x16x32_bf16 v[176:179], a[112:115], v[228:231], v[176:179]
    v_fma_f32 v140, v140, s38, -v153
    v_fma_f32 v141, v141, s38, -v153
    v_mfma_f32_16x16x32_bf16 v[180:183], a[136:139], v[228:231], v[180:183]
    v_fma_f32 v142, v142, s38, -v153
    v_fma_f32 v143, v143, s38, -v153
    v_mfma_f32_16x16x32_bf16 v[188:191], a[20:23], v[232:235], v[188:191]
    v_exp_f32 v140, v140
    s_nop 0
    v_mfma_f32_16x16x32_bf16 v[192:195], a[44:47], v[232:235], v[192:195]
    s_nop 0
    v_exp_f32 v141, v141
    s_nop 0
    v_mfma_f32_16x16x32_bf16 v[196:199], a[68:71], v[232:235], v[196:199]
    s_nop 0
    v_cvt_pk_bf16_f32 v16, v188, v189
    v_cvt_pk_bf16_f32 v17, v190, v191
    v_mfma_f32_16x16x32_bf16 v[172:175], a[92:95], v[232:235], v[172:175]
    v_cvt_pk_bf16_f32 v18, v192, v193
    v_cvt_pk_bf16_f32 v19, v194, v195
    v_mfma_f32_16x16x32_bf16 v[176:179], a[116:119], v[232:235], v[176:179]
    v_fma_f32 v144, v144, s38, -v153
    v_fma_f32 v145, v145, s38, -v153
    v_mfma_f32_16x16x32_bf16 v[180:183], a[140:143], v[232:235], v[180:183]
    v_fma_f32 v146, v146, s38, -v153
    v_fma_f32 v147, v147, s38, -v153
    v_mfma_f32_16x16x32_bf16 v[132:135], v[64:67], v[124:127], 0
    v_exp_f32 v142, v142
    v_mfma_f32_16x16x32_bf16 v[136:139], v[72:75], v[124:127], 0
    v_exp_f32 v143, v143
    v_mfma_f32_16x16x32_bf16 v[156:159], v[80:83], v[124:127], 0
    v_exp_f32 v144, v144
    v_mfma_f32_16x16x32_bf16 v[160:163], v[88:91], v[128:131], v[160:163]
    v_exp_f32 v145, v145
    v_mfma_f32_16x16x32_bf16 v[132:135], v[68:71], v[128:131], v[132:135]
    s_waitcnt lgkmcnt(2)
    v_exp_f32 v146, v146
    v_mfma_f32_16x16x32_bf16 v[136:139], v[76:79], v[128:131], v[136:139]
    v_exp_f32 v147, v147
    v_mfma_f32_16x16x32_bf16 v[156:159], v[84:87], v[128:131], v[156:159]
    v_cvt_pk_bf16_f32 v140, v140, v141
    v_cvt_pk_bf16_f32 v141, v142, v143
    v_mfma_f32_16x16x32_bf16 v[184:187], v[212:215], a[144:147], 0
    s_waitcnt lgkmcnt(1)
    v_cvt_pk_bf16_f32 v142, v144, v145
    v_cvt_pk_bf16_f32 v143, v146, v147
    v_mfma_f32_16x16x32_bf16 v[188:191], v[212:215], a[168:171], 0
    v_fma_f32 v148, v148, s38, -v153
    v_fma_f32 v149, v149, s38, -v153
    v_mfma_f32_16x16x32_bf16 v[192:195], v[212:215], a[192:195], 0
    v_fma_f32 v150, v150, s38, -v153
    v_fma_f32 v151, v151, s38, -v153
    v_mfma_f32_16x16x32_bf16 v[184:187], v[216:219], a[148:151], v[184:187]
    s_waitcnt lgkmcnt(0)
    ds_read_b128 v[224:227], v248 offset:128
    v_fma_f32 v152, v152, s38, -v153
    v_mfma_f32_16x16x32_bf16 v[188:191], v[216:219], a[172:175], v[188:191]
    v_exp_f32 v148, v148
    v_mfma_f32_16x16x32_bf16 v[192:195], v[216:219], a[196:199], v[192:195]
    v_exp_f32 v149, v149
    v_mfma_f32_16x16x32_bf16 v[184:187], v[220:223], a[152:155], v[184:187]
    v_exp_f32 v150, v150
    v_mfma_f32_16x16x32_bf16 v[188:191], v[220:223], a[176:179], v[188:191]
    v_exp_f32 v151, v151
    v_mfma_f32_16x16x32_bf16 v[192:195], v[220:223], a[200:203], v[192:195]
    v_cvt_pk_bf16_f32 v144, v148, v149
    v_cvt_pk_bf16_f32 v145, v150, v151
    v_mfma_f32_16x16x32_bf16 v[168:171], v[88:91], v[140:143], 0
    v_exp_f32 v152, v152
    v_mfma_f32_16x16x32_bf16 v[148:151], v[64:67], v[140:143], 0
    v_cvt_pk_bf16_f32 v146, v152, 0
    v_mov_b32 v147, 0
    v_mfma_f32_16x16x32_bf16 v[152:155], v[72:75], v[140:143], 0
    ds_read_b128 v[228:231], v247 offset:256
    ds_read_b128 v[232:235], v248 offset:256
    v_mfma_f32_16x16x32_bf16 v[164:167], v[80:83], v[140:143], 0
    v_rcp_f32 v160, v160
    v_mfma_f32_16x16x32_bf16 v[168:171], v[88:91], v[144:147], v[168:171]
    ds_read_b128 v[124:127], v250 offset:9216
    v_mul_f32 v132, v132, v160
    v_mfma_f32_16x16x32_bf16 v[148:151], v[68:71], v[144:147], v[148:151]
    s_waitcnt lgkmcnt(3)
    v_mul_f32 v133, v133, v160
    v_mul_f32 v134, v134, v160
    v_mfma_f32_16x16x32_bf16 v[152:155], v[76:79], v[144:147], v[152:155]
    v_mul_f32 v135, v135, v160
    v_cvt_pk_bf16_f32 v132, v132, v133
    v_mfma_f32_16x16x32_bf16 v[164:167], v[84:87], v[144:147], v[164:167]
    v_mul_f32 v136, v136, v160
    v_mul_f32 v137, v137, v160
    v_mfma_f32_16x16x32_bf16 v[184:187], v[224:227], a[156:159], v[184:187]
    v_mul_f32 v138, v138, v160
    v_mul_f32 v139, v139, v160
    v_mfma_f32_16x16x32_bf16 v[188:191], v[224:227], a[180:183], v[188:191]
    v_cvt_pk_bf16_f32 v133, v134, v135
    v_cvt_pk_bf16_f32 v134, v136, v137
    v_mfma_f32_16x16x32_bf16 v[192:195], v[224:227], a[204:207], v[192:195]
    s_waitcnt lgkmcnt(2)
    ds_read_b128 v[128:131], v250 offset:10240
    v_mfma_f32_16x16x32_bf16 v[184:187], v[228:231], a[160:163], v[184:187]
    v_cvt_pk_bf16_f32 v135, v138, v139
    v_cvt_pk_bf16_f32 v20, v196, v197
    v_mfma_f32_16x16x32_bf16 v[188:191], v[228:231], a[184:187], v[188:191]
    s_waitcnt lgkmcnt(2)
    ds_write_b128 v251, v[132:135] offset:30720
    v_mfma_f32_16x16x32_bf16 v[192:195], v[228:231], a[208:211], v[192:195]
    ds_read_b128 v[132:135], v250 offset:11264
    ds_read_b32 v136, v250 offset:12300
    v_mfma_f32_16x16x32_bf16 v[184:187], v[232:235], a[164:167], v[184:187]
    s_waitcnt lgkmcnt(4)
    ds_read_b128 v[212:215], v247 offset:6144
    ds_read_b128 v[216:219], v248 offset:6144
    v_mfma_f32_16x16x32_bf16 v[188:191], v[232:235], a[188:191], v[188:191]
    v_cvt_pk_bf16_f32 v21, v198, v199
    v_cvt_pk_bf16_f32 v48, v172, v173
    v_mfma_f32_16x16x32_bf16 v[192:195], v[232:235], a[212:215], v[192:195]
    ds_read_b128 v[220:223], v247 offset:6272
    v_cvt_pk_bf16_f32 v49, v174, v175
    v_mfma_f32_16x16x32_bf16 v[124:127], v[0:3], v[56:59], v[124:127]
    v_rcp_f32 v168, v168
    s_waitcnt lgkmcnt(6)
    v_mfma_f32_16x16x32_bf16 v[128:131], v[8:11], v[56:59], v[128:131]
    ds_read_b128 v[140:143], v250 offset:0
    v_mul_f32 v148, v148, v168
    v_mfma_f32_16x16x32_bf16 v[124:127], v[4:7], v[60:63], v[124:127]
    v_mul_f32 v149, v149, v168
    v_mul_f32 v150, v150, v168
    v_mfma_f32_16x16x32_bf16 v[128:131], v[12:15], v[60:63], v[128:131]
    v_mul_f32 v151, v151, v168
    v_cvt_pk_bf16_f32 v148, v148, v149
    v_cvt_pk_bf16_f32 v50, v176, v177
    v_cvt_pk_bf16_f32 v51, v178, v179
    v_mul_f32 v152, v152, v168
    v_mul_f32 v153, v153, v168
    v_mul_f32 v154, v154, v168
    v_mul_f32 v155, v155, v168
    v_cvt_pk_bf16_f32 v149, v150, v151
    s_waitcnt lgkmcnt(5)
    v_mfma_f32_16x16x32_bf16 v[132:135], v[16:19], v[56:59], v[132:135]
    s_waitcnt lgkmcnt(4)
    v_cndmask_b32 v136, v254, v136, s[60:61]
    v_mfma_f32_16x16x32_bf16 v[132:135], v[20:23], v[60:63], v[132:135]
    ds_read_b128 v[144:147], v250 offset:1024
    v_cvt_pk_bf16_f32 v150, v152, v153
    v_mfma_f32_16x16x32_bf16 v[136:139], v[24:27], v[56:59], v[136:139]
    s_waitcnt lgkmcnt(4)
    v_cvt_pk_bf16_f32 v151, v154, v155
    v_cvt_pk_bf16_f32 v52, v180, v181
    v_mfma_f32_16x16x32_bf16 v[136:139], v[28:31], v[60:63], v[136:139]
    ds_write_b128 v251, v[148:151] offset:36864
    v_mfma_f32_16x16x32_bf16 v[196:199], v[212:215], a[144:147], 0
    s_waitcnt lgkmcnt(4)
    ds_read_b128 v[148:151], v250 offset:2048
    ds_read_b32 v152, v250 offset:12288
    v_mfma_f32_16x16x32_bf16 v[172:175], v[212:215], a[168:171], 0
    ds_read_b128 v[224:227], v248 offset:6272
    ds_read_b128 v[228:231], v247 offset:6400
    v_mfma_f32_16x16x32_bf16 v[176:179], v[212:215], a[192:195], 0
    ds_read_b128 v[232:235], v248 offset:6400
    ds_read_b128 v[212:215], v249 offset:6144
    v_mfma_f32_16x16x32_bf16 v[196:199], v[216:219], a[148:151], v[196:199]
    s_waitcnt lgkmcnt(9)
    v_cvt_pk_bf16_f32 v53, v182, v183
    v_cvt_pk_bf16_f32 v64, v184, v185
    v_mfma_f32_16x16x32_bf16 v[172:175], v[216:219], a[172:175], v[172:175]
    v_cvt_pk_bf16_f32 v65, v186, v187
    v_cvt_pk_bf16_f32 v72, v188, v189
    v_mfma_f32_16x16x32_bf16 v[176:179], v[216:219], a[196:199], v[176:179]
    ds_read_b128 v[216:219], v249 offset:7168
    v_cvt_pk_bf16_f32 v73, v190, v191
    v_mfma_f32_16x16x32_bf16 v[196:199], v[220:223], a[152:155], v[196:199]
    s_waitcnt lgkmcnt(9)
    v_mul_f32 v156, v156, v160
    v_mul_f32 v157, v157, v160
    v_mfma_f32_16x16x32_bf16 v[172:175], v[220:223], a[176:179], v[172:175]
    s_waitcnt lgkmcnt(8)
    v_mul_f32 v164, v164, v168
    v_mul_f32 v165, v165, v168
    v_mfma_f32_16x16x32_bf16 v[176:179], v[220:223], a[200:203], v[176:179]
    ds_read_b128 v[220:223], v249 offset:8192
    v_mul_f32 v158, v158, v160
    v_mfma_f32_16x16x32_bf16 v[140:143], v[0:3], v[32:35], v[140:143]
    v_mul_f32 v159, v159, v160
    v_mul_f32 v166, v166, v168
    v_mfma_f32_16x16x32_bf16 v[144:147], v[8:11], v[32:35], v[144:147]
    s_waitcnt lgkmcnt(7)
    v_mul_f32 v167, v167, v168
    v_cvt_pk_bf16_f32 v156, v156, v157
    v_mfma_f32_16x16x32_bf16 v[148:151], v[16:19], v[32:35], v[148:151]
    s_waitcnt lgkmcnt(6)
    v_cndmask_b32 v152, v254, v152, s[60:61]
    v_cvt_pk_bf16_f32 v164, v164, v165
    v_mfma_f32_16x16x32_bf16 v[140:143], v[4:7], v[36:39], v[140:143]
    v_cvt_pk_bf16_f32 v157, v158, v159
    v_cvt_pk_bf16_f32 v165, v166, v167
    v_mfma_f32_16x16x32_bf16 v[152:155], v[24:27], v[32:35], v[152:155]
    v_max3_f32 v137, v124, v125, v126
    v_max3_f32 v138, v127, v128, v129
    v_mfma_f32_16x16x32_bf16 v[144:147], v[12:15], v[36:39], v[144:147]
    s_waitcnt lgkmcnt(5)
    v_max3_f32 v137, v137, v130, v131
    v_max3_f32 v138, v138, v132, v133
    v_mfma_f32_16x16x32_bf16 v[148:151], v[20:23], v[36:39], v[148:151]
    v_max3_f32 v137, v137, v134, v135
    v_max3_f32 v137, v137, v138, v136
    v_mfma_f32_16x16x32_bf16 v[152:155], v[28:31], v[36:39], v[152:155]
    v_mov_b32 v138, v137
    v_cvt_pk_bf16_f32 v80, v192, v193
    v_mfma_f32_16x16x32_bf16 v[196:199], v[224:227], a[156:159], v[196:199]
    s_waitcnt lgkmcnt(4)
    v_permlane32_swap_b32 v137, v138
    v_mfma_f32_16x16x32_bf16 v[172:175], v[224:227], a[180:183], v[172:175]
    v_max_f32 v137, v137, v138
    v_cvt_pk_bf16_f32 v81, v194, v195
    v_mfma_f32_16x16x32_bf16 v[176:179], v[224:227], a[204:207], v[176:179]
    ds_read_b128 v[224:227], v249 offset:9216
    v_mov_b32 v138, v137
    v_mfma_f32_16x16x32_bf16 v[196:199], v[228:231], a[160:163], v[196:199]
    s_waitcnt lgkmcnt(4)
    v_permlane16_swap_b32 v137, v138
    v_mfma_f32_16x16x32_bf16 v[172:175], v[228:231], a[184:187], v[172:175]
    v_max_f32 v137, v137, v138
    v_mul_f32 v137, s38, v137
    v_mfma_f32_16x16x32_bf16 v[176:179], v[228:231], a[208:211], v[176:179]
    ds_read_b128 v[228:231], v249 offset:10240
    v_fma_f32 v124, v124, s38, -v137
    v_mfma_f32_16x16x32_bf16 v[196:199], v[232:235], a[164:167], v[196:199]
    s_waitcnt lgkmcnt(4)
    v_fma_f32 v125, v125, s38, -v137
    v_fma_f32 v126, v126, s38, -v137
    v_mfma_f32_16x16x32_bf16 v[172:175], v[232:235], a[188:191], v[172:175]
    v_fma_f32 v127, v127, s38, -v137
    v_fma_f32 v128, v128, s38, -v137
    v_mfma_f32_16x16x32_bf16 v[176:179], v[232:235], a[212:215], v[176:179]
    ds_read_b128 v[232:235], v249 offset:11264
    v_fma_f32 v129, v129, s38, -v137
    v_mfma_f32_16x16x32_bf16 v[200:203], a[216:219], v[212:215], 0
    s_waitcnt lgkmcnt(4)
    v_exp_f32 v124, v124
    v_mfma_f32_16x16x32_bf16 v[204:207], a[240:243], v[212:215], 0
    v_exp_f32 v125, v125
    v_mfma_f32_16x16x32_bf16 v[208:211], v[100:103], v[212:215], 0
    ds_read_b128 v[212:215], v247 offset:12288
    v_fma_f32 v130, v130, s38, -v137
    v_mfma_f32_16x16x32_bf16 v[200:203], a[220:223], v[216:219], v[200:203]
    s_waitcnt lgkmcnt(4)
    v_fma_f32 v131, v131, s38, -v137
    v_cvt_pk_bf16_f32 v124, v124, v125
    v_mfma_f32_16x16x32_bf16 v[204:207], a[244:247], v[216:219], v[204:207]
    v_exp_f32 v126, v126
    v_mfma_f32_16x16x32_bf16 v[208:211], v[104:107], v[216:219], v[208:211]
    ds_read_b128 v[216:219], v248 offset:12288
    v_fma_f32 v132, v132, s38, -v137
    v_mfma_f32_16x16x32_bf16 v[200:203], a[224:227], v[220:223], v[200:203]
    s_waitcnt lgkmcnt(4)
    v_exp_f32 v127, v127
    v_mfma_f32_16x16x32_bf16 v[204:207], a[248:251], v[220:223], v[204:207]
    v_exp_f32 v128, v128
    v_mfma_f32_16x16x32_bf16 v[208:211], v[108:111], v[220:223], v[208:211]
    ds_read_b128 v[220:223], v247 offset:12416
    v_cvt_pk_bf16_f32 v125, v126, v127
    v_mfma_f32_16x16x32_bf16 v[200:203], a[228:231], v[224:227], v[200:203]
    s_waitcnt lgkmcnt(4)
    v_exp_f32 v129, v129
    v_mfma_f32_16x16x32_bf16 v[204:207], a[252:255], v[224:227], v[204:207]
    v_exp_f32 v130, v130
    v_mfma_f32_16x16x32_bf16 v[208:211], v[112:115], v[224:227], v[208:211]
    ds_read_b128 v[224:227], v248 offset:12416
    v_cvt_pk_bf16_f32 v126, v128, v129
    v_mfma_f32_16x16x32_bf16 v[200:203], a[232:235], v[228:231], v[200:203]
    s_waitcnt lgkmcnt(4)
    v_exp_f32 v131, v131
    v_mfma_f32_16x16x32_bf16 v[204:207], v[92:95], v[228:231], v[204:207]
    v_cvt_pk_bf16_f32 v127, v130, v131
    v_fma_f32 v133, v133, s38, -v137
    v_mfma_f32_16x16x32_bf16 v[208:211], v[116:119], v[228:231], v[208:211]
    ds_read_b128 v[228:231], v247 offset:12544
    v_fma_f32 v134, v134, s38, -v137
    v_mfma_f32_16x16x32_bf16 v[200:203], a[236:239], v[232:235], v[200:203]
    s_waitcnt lgkmcnt(4)
    v_fma_f32 v135, v135, s38, -v137
    v_cvt_pk_bf16_f32 v66, v196, v197
    v_mfma_f32_16x16x32_bf16 v[204:207], v[96:99], v[232:235], v[204:207]
L_pad4:
    s_cbranch_execz L_ret4
    v_exp_f32 v132, v132
    v_mfma_f32_16x16x32_bf16 v[208:211], v[120:123], v[232:235], v[208:211]
    s_nop 0
    ds_read_b128 v[232:235], v248 offset:12544
    v_cvt_pk_bf16_f32 v200, v200, v201
    v_mfma_f32_16x16x32_bf16 v[180:183], v[212:215], a[144:147], 0
    s_waitcnt lgkmcnt(4)
    v_cvt_pk_bf16_f32 v201, v202, v203
    v_cvt_pk_bf16_f32 v202, v204, v205
    v_mfma_f32_16x16x32_bf16 v[184:187], v[212:215], a[168:171], 0
    v_cvt_pk_bf16_f32 v203, v206, v207
    v_cvt_pk_bf16_f32 v204, v208, v209
    v_mfma_f32_16x16x32_bf16 v[188:191], v[212:215], a[192:195], 0
    ds_read_b128 v[212:215], v249 offset:12288
    v_cvt_pk_bf16_f32 v205, v210, v211
    v_mfma_f32_16x16x32_bf16 v[180:183], v[216:219], a[148:151], v[180:183]
    s_waitcnt lgkmcnt(4)
    v_exp_f32 v133, v133
    v_mfma_f32_16x16x32_bf16 v[184:187], v[216:219], a[172:175], v[184:187]
    v_exp_f32 v134, v134
    v_mfma_f32_16x16x32_bf16 v[188:191], v[216:219], a[196:199], v[188:191]
    ds_read_b128 v[216:219], v249 offset:13312
    v_cvt_pk_bf16_f32 v67, v198, v199
    v_mfma_f32_16x16x32_bf16 v[180:183], v[220:223], a[152:155], v[180:183]
    s_waitcnt lgkmcnt(4)
    v_exp_f32 v135, v135
    v_mfma_f32_16x16x32_bf16 v[184:187], v[220:223], a[176:179], v[184:187]
    v_fma_f32 v136, v136, s38, -v137
    v_cvt_pk_bf16_f32 v128, v132, v133
    v_mfma_f32_16x16x32_bf16 v[188:191], v[220:223], a[200:203], v[188:191]
    ds_read_b128 v[220:223], v249 offset:14336
    v_cvt_pk_bf16_f32 v129, v134, v135
    v_mfma_f32_16x16x32_bf16 v[180:183], v[224:227], a[156:159], v[180:183]
    s_waitcnt lgkmcnt(4)
    v_max3_f32 v153, v140, v141, v142
    v_max3_f32 v154, v143, v144, v145
    v_mfma_f32_16x16x32_bf16 v[184:187], v[224:227], a[180:183], v[184:187]
    v_exp_f32 v136, v136
    v_mfma_f32_16x16x32_bf16 v[188:191], v[224:227], a[204:207], v[188:191]
    buffer_store_dwordx4 v[200:203], v241, s[32:35], 0 offen sc0 sc1
    v_mfma_f32_16x16x32_bf16 v[180:183], v[228:231], a[160:163], v[180:183]
    s_waitcnt lgkmcnt(3)
    ds_write_b64 v246, v[204:205] offset:0
    v_mfma_f32_16x16x32_bf16 v[184:187], v[228:231], a[184:187], v[184:187]
    ds_read_b128 v[224:227], v249 offset:15360
    v_cvt_pk_bf16_f32 v74, v172, v173
    v_mfma_f32_16x16x32_bf16 v[188:191], v[228:231], a[208:211], v[188:191]
    ds_read_b128 v[228:231], v249 offset:16384
    v_cvt_pk_bf16_f32 v75, v174, v175
    v_mfma_f32_16x16x32_bf16 v[180:183], v[232:235], a[164:167], v[180:183]
    s_waitcnt lgkmcnt(5)
    v_max3_f32 v153, v153, v146, v147
    v_max3_f32 v154, v154, v148, v149
    v_mfma_f32_16x16x32_bf16 v[184:187], v[232:235], a[188:191], v[184:187]
    v_max3_f32 v153, v153, v150, v151
    v_cvt_pk_bf16_f32 v130, v136, 0
    v_mfma_f32_16x16x32_bf16 v[188:191], v[232:235], a[212:215], v[188:191]
    ds_read_b128 v[232:235], v249 offset:17408
    v_max3_f32 v153, v153, v154, v152
    v_mfma_f32_16x16x32_bf16 v[200:203], a[216:219], v[212:215], 0
    s_waitcnt lgkmcnt(5)
    v_mov_b32 v154, v153
    v_cvt_pk_bf16_f32 v82, v176, v177
    v_mfma_f32_16x16x32_bf16 v[204:207], a[240:243], v[212:215], 0
    v_cvt_pk_bf16_f32 v83, v178, v179
    v_mov_b32 v131, 0
    v_mfma_f32_16x16x32_bf16 v[208:211], v[100:103], v[212:215], 0
    ds_read_b128 v[212:215], v249 offset:18432
    v_cvt_pk_bf16_f32 v68, v180, v181
    v_mfma_f32_16x16x32_bf16 v[200:203], a[220:223], v[216:219], v[200:203]
    s_waitcnt lgkmcnt(5)
    v_permlane32_swap_b32 v153, v154
    v_mfma_f32_16x16x32_bf16 v[204:207], a[244:247], v[216:219], v[204:207]
    v_max_f32 v153, v153, v154
    v_mov_b32 v154, v153
    v_mfma_f32_16x16x32_bf16 v[208:211], v[104:107], v[216:219], v[208:211]
    ds_read_b128 v[216:219], v249 offset:19456
    v_cvt_pk_bf16_f32 v69, v182, v183
    v_mfma_f32_16x16x32_bf16 v[200:203], a[224:227], v[220:223], v[200:203]
    s_waitcnt lgkmcnt(4)
    v_permlane16_swap_b32 v153, v154
    v_mfma_f32_16x16x32_bf16 v[204:207], a[248:251], v[220:223], v[204:207]
    v_cvt_pk_bf16_f32 v76, v184, v185
    v_cvt_pk_bf16_f32 v77, v186, v187
    v_mfma_f32_16x16x32_bf16 v[208:211], v[108:111], v[220:223], v[208:211]
    ds_write_b64 v252, v[156:157] offset:30720
    ds_write_b64 v252, v[164:165] offset:36864
    v_mfma_f32_16x16x32_bf16 v[200:203], a[228:231], v[224:227], v[200:203]
    s_waitcnt lgkmcnt(5)
    ds_read_b128 v[220:223], v249 offset:20480
    v_max_f32 v153, v153, v154
    v_mfma_f32_16x16x32_bf16 v[204:207], a[252:255], v[224:227], v[204:207]
    v_mul_f32 v153, s38, v153
    v_fma_f32 v140, v140, s38, -v153
    v_mfma_f32_16x16x32_bf16 v[208:211], v[112:115], v[224:227], v[208:211]
    ds_read_b128 v[224:227], v249 offset:21504
    v_fma_f32 v141, v141, s38, -v153
    v_mfma_f32_16x16x32_bf16 v[200:203], a[232:235], v[228:231], v[200:203]
    s_waitcnt lgkmcnt(6)
    v_fma_f32 v142, v142, s38, -v153
    v_fma_f32 v143, v143, s38, -v153
    v_mfma_f32_16x16x32_bf16 v[204:207], v[92:95], v[228:231], v[204:207]
    v_exp_f32 v140, v140
    v_mfma_f32_16x16x32_bf16 v[208:211], v[116:119], v[228:231], v[208:211]
    ds_read_b128 v[228:231], v249 offset:22528
    v_cvt_pk_bf16_f32 v84, v188, v189
    v_mfma_f32_16x16x32_bf16 v[200:203], a[236:239], v[232:235], v[200:203]
    v_exp_f32 v141, v141
    s_nop 0
    v_mfma_f32_16x16x32_bf16 v[204:207], v[96:99], v[232:235], v[204:207]
    s_nop 0
    v_cvt_pk_bf16_f32 v85, v190, v191
    v_fma_f32 v144, v144, s38, -v153
    v_mfma_f32_16x16x32_bf16 v[208:211], v[120:123], v[232:235], v[208:211]
    s_nop 0
    v_cvt_pk_bf16_f32 v200, v200, v201
    v_cvt_pk_bf16_f32 v201, v202, v203
    v_mfma_f32_16x16x32_bf16 v[160:163], v[88:91], v[124:127], 0
    v_cvt_pk_bf16_f32 v202, v204, v205
    v_cvt_pk_bf16_f32 v203, v206, v207
    v_mfma_f32_16x16x32_bf16 v[132:135], v[64:67], v[124:127], 0
    buffer_store_dwordx4 v[200:203], v242, s[32:35], 0 offen sc0 sc1
    s_waitcnt lgkmcnt(6)
    s_nop 0
    v_mfma_f32_16x16x32_bf16 v[200:203], a[216:219], v[212:215], 0
    s_waitcnt lgkmcnt(5)
    v_cvt_pk_bf16_f32 v204, v208, v209
    v_cvt_pk_bf16_f32 v205, v210, v211
    v_mfma_f32_16x16x32_bf16 v[208:211], v[100:103], v[212:215], 0
    ds_write_b64 v246, v[204:205] offset:2048
    v_mfma_f32_16x16x32_bf16 v[204:207], a[240:243], v[212:215], 0
    ds_read_b128 v[232:235], v249 offset:23552
    v_fma_f32 v145, v145, s38, -v153
    v_mfma_f32_16x16x32_bf16 v[200:203], a[220:223], v[216:219], v[200:203]
    s_waitcnt lgkmcnt(4)
    v_fma_f32 v146, v146, s38, -v153
    v_fma_f32 v147, v147, s38, -v153
    v_mfma_f32_16x16x32_bf16 v[204:207], a[244:247], v[216:219], v[204:207]
    v_exp_f32 v142, v142
    v_mfma_f32_16x16x32_bf16 v[208:211], v[104:107], v[216:219], v[208:211]
    v_exp_f32 v143, v143
    v_mfma_f32_16x16x32_bf16 v[200:203], a[224:227], v[220:223], v[200:203]
    s_waitcnt lgkmcnt(3)
    v_exp_f32 v144, v144
    v_mfma_f32_16x16x32_bf16 v[204:207], a[248:251], v[220:223], v[204:207]
    v_exp_f32 v145, v145
    v_mfma_f32_16x16x32_bf16 v[208:211], v[108:111], v[220:223], v[208:211]
    v_exp_f32 v146, v146
    v_mfma_f32_16x16x32_bf16 v[200:203], a[228:231], v[224:227], v[200:203]
    s_waitcnt lgkmcnt(2)
    v_exp_f32 v147, v147
    v_mfma_f32_16x16x32_bf16 v[204:207], a[252:255], v[224:227], v[204:207]
    v_cvt_pk_bf16_f32 v140, v140, v141
    v_cvt_pk_bf16_f32 v141, v142, v143
    v_mfma_f32_16x16x32_bf16 v[208:211], v[112:115], v[224:227], v[208:211]
    v_cvt_pk_bf16_f32 v142, v144, v145
    v_cvt_pk_bf16_f32 v143, v146, v147
    v_mfma_f32_16x16x32_bf16 v[200:203], a[232:235], v[228:231], v[200:203]
    s_waitcnt lgkmcnt(0)
    v_fma_f32 v148, v148, s38, -v153
    v_mfma_f32_16x16x32_bf16 v[204:207], v[92:95], v[228:231], v[204:207]
    v_fma_f32 v149, v149, s38, -v153
    v_fma_f32 v150, v150, s38, -v153
    v_mfma_f32_16x16x32_bf16 v[208:211], v[116:119], v[228:231], v[208:211]
    v_fma_f32 v151, v151, s38, -v153
    v_fma_f32 v152, v152, s38, -v153
    v_mfma_f32_16x16x32_bf16 v[200:203], a[236:239], v[232:235], v[200:203]
    v_exp_f32 v148, v148
    s_nop 0
    v_mfma_f32_16x16x32_bf16 v[204:207], v[96:99], v[232:235], v[204:207]
    s_nop 0
    v_exp_f32 v149, v149
    s_nop 0
    v_mfma_f32_16x16x32_bf16 v[208:211], v[120:123], v[232:235], v[208:211]
    s_nop 0
    v_cvt_pk_bf16_f32 v200, v200, v201
    v_cvt_pk_bf16_f32 v201, v202, v203
    v_mfma_f32_16x16x32_bf16 v[136:139], v[72:75], v[124:127], 0
    v_cvt_pk_bf16_f32 v202, v204, v205
    v_cvt_pk_bf16_f32 v144, v148, v149
    v_mfma_f32_16x16x32_bf16 v[156:159], v[80:83], v[124:127], 0
    s_nop 0
    v_cvt_pk_bf16_f32 v204, v208, v209
    v_cvt_pk_bf16_f32 v205, v210, v211
    v_mfma_f32_16x16x32_bf16 v[160:163], v[88:91], v[128:131], v[160:163]
    ds_write_b64 v246, v[204:205] offset:4096
    v_mfma_f32_16x16x32_bf16 v[132:135], v[68:71], v[128:131], v[132:135]
    v_exp_f32 v150, v150
    v_mfma_f32_16x16x32_bf16 v[136:139], v[76:79], v[128:131], v[136:139]
    v_exp_f32 v151, v151
    v_mfma_f32_16x16x32_bf16 v[156:159], v[84:87], v[128:131], v[156:159]
    v_cvt_pk_bf16_f32 v145, v150, v151
    v_mov_b32 v147, 0
    v_mfma_f32_16x16x32_bf16 v[168:171], v[88:91], v[140:143], 0
    v_exp_f32 v152, v152
    v_mfma_f32_16x16x32_bf16 v[148:151], v[64:67], v[140:143], 0
    v_cvt_pk_bf16_f32 v146, v152, 0
    v_cvt_pk_bf16_f32 v203, v206, v207
    v_mfma_f32_16x16x32_bf16 v[152:155], v[72:75], v[140:143], 0
    v_rcp_f32 v160, v160
    v_mfma_f32_16x16x32_bf16 v[164:167], v[80:83], v[140:143], 0
    ds_read_b128 v[124:127], v250 offset:3072
    v_mul_f32 v132, v132, v160
    v_mfma_f32_16x16x32_bf16 v[168:171], v[88:91], v[144:147], v[168:171]
    v_mul_f32 v133, v133, v160
    v_mul_f32 v134, v134, v160
    v_mfma_f32_16x16x32_bf16 v[148:151], v[68:71], v[144:147], v[148:151]
    v_mul_f32 v135, v135, v160
    v_cvt_pk_bf16_f32 v132, v132, v133
    v_mfma_f32_16x16x32_bf16 v[152:155], v[76:79], v[144:147], v[152:155]
    s_waitcnt vmcnt(2) lgkmcnt(1)
    s_barrier
    ds_read_b128 v[220:223], v247 offset:18432
    v_mfma_f32_16x16x32_bf16 v[164:167], v[84:87], v[144:147], v[164:167]
    ds_read_b128 v[224:227], v248 offset:18432
    ds_read_b128 v[228:231], v247 offset:18560
    v_mul_f32 v136, v136, v160
    v_mul_f32 v137, v137, v160
    v_mul_f32 v138, v138, v160
    v_mul_f32 v139, v139, v160
    v_cvt_pk_bf16_f32 v133, v134, v135
    v_cvt_pk_bf16_f32 v134, v136, v137
    v_cvt_pk_bf16_f32 v135, v138, v139
    ds_read_b128 v[128:131], v250 offset:4096
    ds_read_b32 v136, v250 offset:12292
    ds_read_b128 v[212:215], v236 offset:0
    ds_read_b128 v[232:235], v248 offset:18560
    ds_read_b128 v[216:219], v236 offset:1024
    s_waitcnt lgkmcnt(8)
    v_mfma_f32_16x16x32_bf16 v[124:127], v[0:3], v[40:43], v[124:127]
    v_rcp_f32 v168, v168
    v_mfma_f32_16x16x32_bf16 v[124:127], v[4:7], v[44:47], v[124:127]
    s_mov_b64 exec, s[68:69]
    ds_write_b128 v251, v[132:135] offset:0
    s_mov_b64 exec, -1
    s_waitcnt lgkmcnt(8)
    v_mfma_f32_16x16x32_bf16 v[192:195], a[0:3], v[220:223], 0
    ds_read_b128 v[132:135], v250 offset:5120
    ds_read_b128 v[140:143], v250 offset:6144
    v_mfma_f32_16x16x32_bf16 v[196:199], a[24:27], v[220:223], 0
    v_mul_f32 v148, v148, v168
    v_mul_f32 v149, v149, v168
    v_mfma_f32_16x16x32_bf16 v[172:175], a[48:51], v[220:223], 0
    v_mul_f32 v150, v150, v168
    v_mul_f32 v151, v151, v168
    v_mfma_f32_16x16x32_bf16 v[176:179], a[72:75], v[220:223], 0
    s_waitcnt lgkmcnt(9)
    v_cvt_pk_bf16_f32 v148, v148, v149
    v_mul_f32 v152, v152, v168
    v_mfma_f32_16x16x32_bf16 v[180:183], a[96:99], v[220:223], 0
    v_mul_f32 v153, v153, v168
    v_mul_f32 v154, v154, v168
    v_mfma_f32_16x16x32_bf16 v[184:187], a[120:123], v[220:223], 0
    v_mul_f32 v155, v155, v168
    v_cvt_pk_bf16_f32 v149, v150, v151
    v_mfma_f32_16x16x32_bf16 v[192:195], a[4:7], v[224:227], v[192:195]
    ds_read_b128 v[144:147], v250 offset:7168
    v_cvt_pk_bf16_f32 v150, v152, v153
    v_mfma_f32_16x16x32_bf16 v[196:199], a[28:31], v[224:227], v[196:199]
    v_cvt_pk_bf16_f32 v151, v154, v155
    v_mul_f32 v156, v156, v160
    v_mfma_f32_16x16x32_bf16 v[172:175], a[52:55], v[224:227], v[172:175]
    ds_read_b32 v152, v250 offset:12296
    ds_read_b128 v[220:223], v247 offset:24576
    v_mfma_f32_16x16x32_bf16 v[176:179], a[76:79], v[224:227], v[176:179]
    s_waitcnt lgkmcnt(11)
    v_mul_f32 v157, v157, v160
    v_mul_f32 v164, v164, v168
    v_mfma_f32_16x16x32_bf16 v[180:183], a[100:103], v[224:227], v[180:183]
    v_mul_f32 v165, v165, v168
    v_mul_f32 v158, v158, v160
    v_mfma_f32_16x16x32_bf16 v[184:187], a[124:127], v[224:227], v[184:187]
    ds_read_b128 v[224:227], v248 offset:24576
    v_mul_f32 v159, v159, v160
    v_mfma_f32_16x16x32_bf16 v[192:195], a[8:11], v[228:231], v[192:195]
    v_mul_f32 v166, v166, v168
    v_mul_f32 v167, v167, v168
    v_mfma_f32_16x16x32_bf16 v[196:199], a[32:35], v[228:231], v[196:199]
    v_cvt_pk_bf16_f32 v156, v156, v157
    v_cvt_pk_bf16_f32 v164, v164, v165
    v_mfma_f32_16x16x32_bf16 v[172:175], a[56:59], v[228:231], v[172:175]
    v_cvt_pk_bf16_f32 v157, v158, v159
    v_cvt_pk_bf16_f32 v165, v166, v167
    v_mfma_f32_16x16x32_bf16 v[176:179], a[80:83], v[228:231], v[176:179]
    v_mov_b32 v237, 0x3f8041d3
    v_cndmask_b32 v38, 0, v237, s[4:5]
    v_mfma_f32_16x16x32_bf16 v[180:183], a[104:107], v[228:231], v[180:183]
    s_waitcnt lgkmcnt(10)
    v_cndmask_b32 v136, v254, v136, s[60:61]
    v_cndmask_b32 v39, 0, v237, s[10:11]
    v_mfma_f32_16x16x32_bf16 v[184:187], a[128:131], v[228:231], v[184:187]
    s_waitcnt lgkmcnt(5)
    buffer_store_dwordx4 v[212:215], v244, s[32:35], 0 offen sc0 sc1
    v_mfma_f32_16x16x32_bf16 v[128:131], v[8:11], v[40:43], v[128:131]
    s_nop 0
    ds_read_b128 v[212:215], v247 offset:18688
    ds_read_b128 v[228:231], v247 offset:24704
    v_mfma_f32_16x16x32_bf16 v[132:135], v[16:19], v[40:43], v[132:135]
    v_mov_b32 v240, s74
    v_cndmask_b32 v255, 0, v240, s[78:79]
    v_mfma_f32_16x16x32_bf16 v[136:139], v[24:27], v[40:43], v[136:139]
    s_add_u32 s78, s40, 518400
    v_sub_u32 v255, 8064, v255
    v_mfma_f32_16x16x32_bf16 v[128:131], v[12:15], v[44:47], v[128:131]
    s_mov_b64 exec, s[54:55]
    buffer_store_dwordx4 v[216:219], v245, s[32:35], 0 offen sc0 sc1
    s_mov_b64 exec, -1
    s_mul_i32 s79, s39, 19267584
    s_sub_u32 s78, s78, s79
    v_mfma_f32_16x16x32_bf16 v[132:135], v[20:23], v[44:47], v[132:135]
    ds_read_b128 v[216:219], v248 offset:18688
    v_bfe_u32 v239, v253, 5, 1
    v_mfma_f32_16x16x32_bf16 v[136:139], v[28:31], v[44:47], v[136:139]
    v_cndmask_b32 v46, 0, v237, s[6:7]
    v_cndmask_b32 v47, 0, v237, s[10:11]
    v_mfma_f32_16x16x32_bf16 v[192:195], a[12:15], v[232:235], v[192:195]
    s_nop 0
    v_mul_u32_u24 v239, s74, v239
    v_sub_u32 v239, 8064, v239
    v_mfma_f32_16x16x32_bf16 v[196:199], a[36:39], v[232:235], v[196:199]
    s_nop 0
    v_max3_f32 v137, v124, v125, v126
    v_max3_f32 v138, v127, v128, v129
    v_mfma_f32_16x16x32_bf16 v[172:175], a[60:63], v[232:235], v[172:175]
    v_max3_f32 v137, v137, v130, v131
    v_max3_f32 v138, v138, v132, v133
    v_mfma_f32_16x16x32_bf16 v[176:179], a[84:87], v[232:235], v[176:179]
    s_waitcnt lgkmcnt(2)
    v_cndmask_b32 v152, v254, v152, s[60:61]
    v_max3_f32 v137, v137, v134, v135
    v_mfma_f32_16x16x32_bf16 v[180:183], a[108:111], v[232:235], v[180:183]
    v_max3_f32 v137, v137, v138, v136
    v_mov_b32 v138, v137
    v_mfma_f32_16x16x32_bf16 v[184:187], a[132:135], v[232:235], v[184:187]
    ds_write_b128 v251, v[148:151] offset:6144
    v_mfma_f32_16x16x32_bf16 v[192:195], a[16:19], v[212:215], v[192:195]
    ds_read_b128 v[148:151], v250 offset:8192
    ds_read_b128 v[232:235], v248 offset:24704
    v_mfma_f32_16x16x32_bf16 v[196:199], a[40:43], v[212:215], v[196:199]
    v_permlane32_swap_b32 v137, v138
    v_mfma_f32_16x16x32_bf16 v[172:175], a[64:67], v[212:215], v[172:175]
    v_max_f32 v137, v137, v138
    v_mov_b32 v138, v137
    v_mfma_f32_16x16x32_bf16 v[176:179], a[88:91], v[212:215], v[176:179]
    s_waitcnt lgkmcnt(3)
    v_permlane16_swap_b32 v137, v138
    v_mfma_f32_16x16x32_bf16 v[180:183], a[112:115], v[212:215], v[180:183]
    v_max_f32 v137, v137, v138
    v_mul_f32 v137, s38, v137
    v_mfma_f32_16x16x32_bf16 v[184:187], a[136:139], v[212:215], v[184:187]
    ds_read_b128 v[212:215], v247 offset:24832
    v_fma_f32 v124, v124, s38, -v137
    v_mfma_f32_16x16x32_bf16 v[192:195], a[20:23], v[216:219], v[192:195]
    v_fma_f32 v125, v125, s38, -v137
    v_fma_f32 v126, v126, s38, -v137
    v_mfma_f32_16x16x32_bf16 v[196:199], a[44:47], v[216:219], v[196:199]
    v_fma_f32 v127, v127, s38, -v137
    v_fma_f32 v128, v128, s38, -v137
    v_mfma_f32_16x16x32_bf16 v[172:175], a[68:71], v[216:219], v[172:175]
    v_exp_f32 v124, v124
    v_mfma_f32_16x16x32_bf16 v[176:179], a[92:95], v[216:219], v[176:179]
    v_exp_f32 v125, v125
    s_nop 0
    v_mfma_f32_16x16x32_bf16 v[180:183], a[116:119], v[216:219], v[180:183]
    s_nop 0
    v_fma_f32 v129, v129, s38, -v137
    v_fma_f32 v130, v130, s38, -v137
    v_mfma_f32_16x16x32_bf16 v[184:187], a[140:143], v[216:219], v[184:187]
    s_waitcnt lgkmcnt(2)
    v_cvt_pk_bf16_f32 v32, v176, v177
    v_cvt_pk_bf16_f32 v33, v178, v179
    v_mfma_f32_16x16x32_bf16 v[140:143], v[0:3], v[48:51], v[140:143]
    v_cvt_pk_bf16_f32 v0, v192, v193
    v_cvt_pk_bf16_f32 v1, v194, v195
    v_mfma_f32_16x16x32_bf16 v[144:147], v[8:11], v[48:51], v[144:147]
    v_cvt_pk_bf16_f32 v2, v196, v197
    v_cvt_pk_bf16_f32 v3, v198, v199
    v_mfma_f32_16x16x32_bf16 v[148:151], v[16:19], v[48:51], v[148:151]
    v_cvt_pk_bf16_f32 v34, v180, v181
    v_cvt_pk_bf16_f32 v35, v182, v183
    v_mfma_f32_16x16x32_bf16 v[152:155], v[24:27], v[48:51], v[152:155]
    ds_read_b128 v[216:219], v248 offset:24832
    v_cvt_pk_bf16_f32 v36, v184, v185
    v_mfma_f32_16x16x32_bf16 v[140:143], v[4:7], v[52:55], v[140:143]
    v_cvt_pk_bf16_f32 v4, v172, v173
    v_cvt_pk_bf16_f32 v5, v174, v175
    v_mfma_f32_16x16x32_bf16 v[144:147], v[12:15], v[52:55], v[144:147]
    v_cvt_pk_bf16_f32 v37, v186, v187
    v_fma_f32 v131, v131, s38, -v137
    v_mfma_f32_16x16x32_bf16 v[148:151], v[20:23], v[52:55], v[148:151]
    v_exp_f32 v126, v126
    v_mfma_f32_16x16x32_bf16 v[152:155], v[28:31], v[52:55], v[152:155]
    v_exp_f32 v127, v127
    v_mfma_f32_16x16x32_bf16 v[188:191], a[0:3], v[220:223], 0
    v_exp_f32 v128, v128
    v_mfma_f32_16x16x32_bf16 v[192:195], a[24:27], v[220:223], 0
    v_exp_f32 v129, v129
    v_mfma_f32_16x16x32_bf16 v[196:199], a[48:51], v[220:223], 0
    v_exp_f32 v130, v130
    v_mfma_f32_16x16x32_bf16 v[172:175], a[72:75], v[220:223], 0
    v_exp_f32 v131, v131
    v_mfma_f32_16x16x32_bf16 v[176:179], a[96:99], v[220:223], 0
    v_cvt_pk_bf16_f32 v124, v124, v125
    v_cvt_pk_bf16_f32 v125, v126, v127
    v_mfma_f32_16x16x32_bf16 v[180:183], a[120:123], v[220:223], 0
    ds_read_b128 v[220:223], v247 offset:30720
    v_cvt_pk_bf16_f32 v126, v128, v129
    v_mfma_f32_16x16x32_bf16 v[188:191], a[4:7], v[224:227], v[188:191]
    v_cvt_pk_bf16_f32 v127, v130, v131
    v_fma_f32 v132, v132, s38, -v137
    v_mfma_f32_16x16x32_bf16 v[192:195], a[28:31], v[224:227], v[192:195]
    v_fma_f32 v133, v133, s38, -v137
    v_fma_f32 v134, v134, s38, -v137
    v_mfma_f32_16x16x32_bf16 v[196:199], a[52:55], v[224:227], v[196:199]
    v_fma_f32 v135, v135, s38, -v137
    v_fma_f32 v136, v136, s38, -v137
    v_mfma_f32_16x16x32_bf16 v[172:175], a[76:79], v[224:227], v[172:175]
    v_exp_f32 v132, v132
    v_mfma_f32_16x16x32_bf16 v[176:179], a[100:103], v[224:227], v[176:179]
    v_exp_f32 v133, v133
    v_mfma_f32_16x16x32_bf16 v[180:183], a[124:127], v[224:227], v[180:183]
    ds_read_b128 v[224:227], v248 offset:30720
    v_cvt_pk_bf16_f32 v128, v132, v133
    v_mfma_f32_16x16x32_bf16 v[188:191], a[8:11], v[228:231], v[188:191]
    v_exp_f32 v134, v134
    v_mfma_f32_16x16x32_bf16 v[192:195], a[32:35], v[228:231], v[192:195]
    v_exp_f32 v135, v135
    v_mfma_f32_16x16x32_bf16 v[196:199], a[56:59], v[228:231], v[196:199]
    v_cvt_pk_bf16_f32 v129, v134, v135
    v_mov_b32 v131, 0
    v_mfma_f32_16x16x32_bf16 v[172:175], a[80:83], v[228:231], v[172:175]
    s_waitcnt lgkmcnt(4)
    v_exp_f32 v136, v136
    v_mfma_f32_16x16x32_bf16 v[176:179], a[104:107], v[228:231], v[176:179]
    v_cvt_pk_bf16_f32 v130, v136, 0
    v_max3_f32 v153, v140, v141, v142
    v_mfma_f32_16x16x32_bf16 v[180:183], a[128:131], v[228:231], v[180:183]
    ds_read_b128 v[228:231], v247 offset:30848
    v_max3_f32 v154, v143, v144, v145
    v_mfma_f32_16x16x32_bf16 v[188:191], a[12:15], v[232:235], v[188:191]
    v_max3_f32 v153, v153, v146, v147
    v_max3_f32 v154, v154, v148, v149
    v_mfma_f32_16x16x32_bf16 v[192:195], a[36:39], v[232:235], v[192:195]
    buffer_store_dwordx4 v[200:203], v243, s[32:35], 0 offen sc0 sc1
    v_mfma_f32_16x16x32_bf16 v[196:199], a[60:63], v[232:235], v[196:199]
    v_max3_f32 v153, v153, v150, v151
    v_max3_f32 v153, v153, v154, v152
    v_mfma_f32_16x16x32_bf16 v[172:175], a[84:87], v[232:235], v[172:175]
    s_waitcnt lgkmcnt(4)
    v_mov_b32 v154, v153
    v_cndmask_b32 v54, 0, v237, s[8:9]
    v_mfma_f32_16x16x32_bf16 v[176:179], a[108:111], v[232:235], v[176:179]
    v_permlane32_swap_b32 v153, v154
    v_mfma_f32_16x16x32_bf16 v[180:183], a[132:135], v[232:235], v[180:183]
    ds_read_b128 v[232:235], v248 offset:30848
    v_max_f32 v153, v153, v154
    v_mfma_f32_16x16x32_bf16 v[188:191], a[16:19], v[212:215], v[188:191]
    v_mov_b32 v154, v153
    v_cndmask_b32 v55, 0, v237, s[10:11]
    v_mfma_f32_16x16x32_bf16 v[192:195], a[40:43], v[212:215], v[192:195]
    v_permlane16_swap_b32 v153, v154
    v_mfma_f32_16x16x32_bf16 v[196:199], a[64:67], v[212:215], v[196:199]
    v_max_f32 v153, v153, v154
    v_mul_f32 v153, s38, v153
    v_mfma_f32_16x16x32_bf16 v[172:175], a[88:91], v[212:215], v[172:175]
    s_waitcnt lgkmcnt(4)
    v_fma_f32 v140, v140, s38, -v153
    v_fma_f32 v141, v141, s38, -v153
    v_mfma_f32_16x16x32_bf16 v[176:179], a[112:115], v[212:215], v[176:179]
    v_fma_f32 v142, v142, s38, -v153
    v_fma_f32 v143, v143, s38, -v153
    v_mfma_f32_16x16x32_bf16 v[180:183], a[136:139], v[212:215], v[180:183]
    ds_read_b128 v[212:215], v247 offset:30976
    v_fma_f32 v144, v144, s38, -v153
    v_mfma_f32_16x16x32_bf16 v[188:191], a[20:23], v[216:219], v[188:191]
    v_exp_f32 v140, v140
    s_nop 0
    v_mfma_f32_16x16x32_bf16 v[192:195], a[44:47], v[216:219], v[192:195]
    s_nop 0
    v_exp_f32 v141, v141
    s_nop 0
    v_mfma_f32_16x16x32_bf16 v[196:199], a[68:71], v[216:219], v[196:199]
    s_nop 0
    v_cvt_pk_bf16_f32 v8, v188, v189
    v_cvt_pk_bf16_f32 v9, v190, v191
    v_mfma_f32_16x16x32_bf16 v[172:175], a[92:95], v[216:219], v[172:175]
    s_waitcnt lgkmcnt(4)
    v_cvt_pk_bf16_f32 v10, v192, v193
    v_cvt_pk_bf16_f32 v11, v194, v195
    v_mfma_f32_16x16x32_bf16 v[176:179], a[116:119], v[216:219], v[176:179]
    v_cvt_pk_bf16_f32 v12, v196, v197
    v_cvt_pk_bf16_f32 v13, v198, v199
    v_mfma_f32_16x16x32_bf16 v[180:183], a[140:143], v[216:219], v[180:183]
    s_mov_b64 exec, s[68:69]
    ds_write_b64 v252, v[156:157] offset:0
    s_mov_b64 exec, -1
    ds_write_b64 v252, v[164:165] offset:6144
    v_mfma_f32_16x16x32_bf16 v[184:187], a[0:3], v[220:223], 0
    v_cvt_pk_bf16_f32 v40, v172, v173
    v_cvt_pk_bf16_f32 v41, v174, v175
    v_mfma_f32_16x16x32_bf16 v[188:191], a[24:27], v[220:223], 0
    v_cvt_pk_bf16_f32 v42, v176, v177
    v_cvt_pk_bf16_f32 v43, v178, v179
    v_mfma_f32_16x16x32_bf16 v[192:195], a[48:51], v[220:223], 0
    ds_read_b128 v[216:219], v248 offset:30976
    v_cvt_pk_bf16_f32 v44, v180, v181
    v_mfma_f32_16x16x32_bf16 v[196:199], a[72:75], v[220:223], 0
    s_waitcnt lgkmcnt(6)
    v_cvt_pk_bf16_f32 v45, v182, v183
    v_fma_f32 v145, v145, s38, -v153
    v_mfma_f32_16x16x32_bf16 v[172:175], a[96:99], v[220:223], 0
    v_fma_f32 v146, v146, s38, -v153
    v_fma_f32 v147, v147, s38, -v153
    v_mfma_f32_16x16x32_bf16 v[176:179], a[120:123], v[220:223], 0
    ds_read_b128 v[220:223], v247 offset:18432
    v_cvt_pk_bf16_f32 v140, v140, v141
    v_mfma_f32_16x16x32_bf16 v[184:187], a[4:7], v[224:227], v[184:187]
    v_exp_f32 v142, v142
    v_mfma_f32_16x16x32_bf16 v[188:191], a[28:31], v[224:227], v[188:191]
    v_exp_f32 v143, v143
    v_mfma_f32_16x16x32_bf16 v[192:195], a[52:55], v[224:227], v[192:195]
    v_exp_f32 v144, v144
    v_mfma_f32_16x16x32_bf16 v[196:199], a[76:79], v[224:227], v[196:199]
    s_waitcnt lgkmcnt(6)
    v_exp_f32 v145, v145
    v_mfma_f32_16x16x32_bf16 v[172:175], a[100:103], v[224:227], v[172:175]
    v_exp_f32 v146, v146
    v_mfma_f32_16x16x32_bf16 v[176:179], a[124:127], v[224:227], v[176:179]
    ds_read_b128 v[224:227], v248 offset:18432
    v_cvt_pk_bf16_f32 v141, v142, v143
    v_mfma_f32_16x16x32_bf16 v[184:187], a[8:11], v[228:231], v[184:187]
    v_exp_f32 v147, v147
    v_mfma_f32_16x16x32_bf16 v[188:191], a[32:35], v[228:231], v[188:191]
    v_cvt_pk_bf16_f32 v142, v144, v145
    v_cvt_pk_bf16_f32 v143, v146, v147
    v_mfma_f32_16x16x32_bf16 v[192:195], a[56:59], v[228:231], v[192:195]
    v_fma_f32 v148, v148, s38, -v153
    v_fma_f32 v149, v149, s38, -v153
    v_mfma_f32_16x16x32_bf16 v[196:199], a[80:83], v[228:231], v[196:199]
    s_waitcnt lgkmcnt(6)
    v_fma_f32 v150, v150, s38, -v153
    v_fma_f32 v151, v151, s38, -v153
    v_mfma_f32_16x16x32_bf16 v[172:175], a[104:107], v[228:231], v[172:175]
    v_exp_f32 v148, v148
    v_mfma_f32_16x16x32_bf16 v[176:179], a[128:131], v[228:231], v[176:179]
    ds_read_b128 v[228:231], v247 offset:18560
    v_fma_f32 v152, v152, s38, -v153
    v_mfma_f32_16x16x32_bf16 v[184:187], a[12:15], v[232:235], v[184:187]
    v_exp_f32 v149, v149
    v_mfma_f32_16x16x32_bf16 v[188:191], a[36:39], v[232:235], v[188:191]
    v_exp_f32 v150, v150
    v_mfma_f32_16x16x32_bf16 v[192:195], a[60:63], v[232:235], v[192:195]
    v_exp_f32 v151, v151
    v_mfma_f32_16x16x32_bf16 v[196:199], a[84:87], v[232:235], v[196:199]
    s_waitcnt lgkmcnt(6)
    v_cvt_pk_bf16_f32 v144, v148, v149
    v_cvt_pk_bf16_f32 v145, v150, v151
    v_mfma_f32_16x16x32_bf16 v[172:175], a[108:111], v[232:235], v[172:175]
    v_exp_f32 v152, v152
    v_mfma_f32_16x16x32_bf16 v[176:179], a[132:135], v[232:235], v[176:179]
    ds_read_b128 v[232:235], v248 offset:18560
    v_cvt_pk_bf16_f32 v146, v152, 0
    v_mfma_f32_16x16x32_bf16 v[184:187], a[16:19], v[212:215], v[184:187]
    v_mov_b32 v147, 0
    v_mfma_f32_16x16x32_bf16 v[188:191], a[40:43], v[212:215], v[188:191]
    v_mfma_f32_16x16x32_bf16 v[192:195], a[64:67], v[212:215], v[192:195]
    v_mfma_f32_16x16x32_bf16 v[196:199], a[88:91], v[212:215], v[196:199]
    s_waitcnt lgkmcnt(4)
    v_mfma_f32_16x16x32_bf16 v[172:175], a[112:115], v[212:215], v[172:175]
    v_mfma_f32_16x16x32_bf16 v[176:179], a[136:139], v[212:215], v[176:179]
    ds_read_b128 v[212:215], v247 offset:18688
    v_mfma_f32_16x16x32_bf16 v[184:187], a[20:23], v[216:219], v[184:187]
    s_nop 0
    v_mfma_f32_16x16x32_bf16 v[188:191], a[44:47], v[216:219], v[188:191]
    s_nop 0
    v_mfma_f32_16x16x32_bf16 v[192:195], a[68:71], v[216:219], v[192:195]
    s_nop 0
    v_mfma_f32_16x16x32_bf16 v[196:199], a[92:95], v[216:219], v[196:199]
    s_nop 0
    s_nop 0
    v_cvt_pk_bf16_f32 v16, v184, v185
    v_mfma_f32_16x16x32_bf16 v[172:175], a[116:119], v[216:219], v[172:175]
    v_cvt_pk_bf16_f32 v17, v186, v187
    v_cvt_pk_bf16_f32 v18, v188, v189
    v_mfma_f32_16x16x32_bf16 v[176:179], a[140:143], v[216:219], v[176:179]
    v_cvt_pk_bf16_f32 v19, v190, v191
    v_cvt_pk_bf16_f32 v20, v192, v193
    v_mfma_f32_16x16x32_bf16 v[160:163], v[88:91], v[124:127], 0
    ds_read_b128 v[216:219], v248 offset:18688
    v_cvt_pk_bf16_f32 v21, v194, v195
    v_mfma_f32_16x16x32_bf16 v[132:135], v[64:67], v[124:127], 0
L_pad5:
    s_cbranch_execz L_ret5
    v_cvt_pk_bf16_f32 v48, v196, v197
    v_cvt_pk_bf16_f32 v49, v198, v199
    v_mfma_f32_16x16x32_bf16 v[136:139], v[72:75], v[124:127], 0
    v_cvt_pk_bf16_f32 v50, v172, v173
    v_cvt_pk_bf16_f32 v51, v174, v175
    v_mfma_f32_16x16x32_bf16 v[156:159], v[80:83], v[124:127], 0
    ds_read_b128 v[124:127], v250 offset:9216
    v_cvt_pk_bf16_f32 v52, v176, v177
    v_mfma_f32_16x16x32_bf16 v[160:163], v[88:91], v[128:131], v[160:163]
    s_nop 0
    v_cvt_pk_bf16_f32 v53, v178, v179
    v_mfma_f32_16x16x32_bf16 v[132:135], v[68:71], v[128:131], v[132:135]
    s_waitcnt lgkmcnt(6)
    v_mfma_f32_16x16x32_bf16 v[136:139], v[76:79], v[128:131], v[136:139]
    s_nop 0
    v_mfma_f32_16x16x32_bf16 v[156:159], v[84:87], v[128:131], v[156:159]
    s_nop 0
    v_rcp_f32 v160, v160
    v_mfma_f32_16x16x32_bf16 v[180:183], v[220:223], a[144:147], 0
    s_waitcnt lgkmcnt(5)
    v_mul_f32 v132, v132, v160
    v_mul_f32 v133, v133, v160
    v_mfma_f32_16x16x32_bf16 v[184:187], v[220:223], a[168:171], 0
    v_mul_f32 v134, v134, v160
    v_mul_f32 v135, v135, v160
    v_mfma_f32_16x16x32_bf16 v[188:191], v[220:223], a[192:195], 0
    v_cvt_pk_bf16_f32 v132, v132, v133
    v_mul_f32 v136, v136, v160
    v_mfma_f32_16x16x32_bf16 v[180:183], v[224:227], a[148:151], v[180:183]
    s_waitcnt lgkmcnt(4)
    v_mul_f32 v137, v137, v160
    v_mul_f32 v138, v138, v160
    v_mfma_f32_16x16x32_bf16 v[184:187], v[224:227], a[172:175], v[184:187]
    v_mul_f32 v139, v139, v160
    v_cvt_pk_bf16_f32 v133, v134, v135
    v_mfma_f32_16x16x32_bf16 v[188:191], v[224:227], a[196:199], v[188:191]
    ds_read_b128 v[128:131], v250 offset:10240
    v_cvt_pk_bf16_f32 v134, v136, v137
    v_mfma_f32_16x16x32_bf16 v[180:183], v[228:231], a[152:155], v[180:183]
    v_cvt_pk_bf16_f32 v135, v138, v139
    v_mul_f32 v156, v156, v160
    v_mfma_f32_16x16x32_bf16 v[184:187], v[228:231], a[176:179], v[184:187]
    ds_read_b32 v136, v250 offset:12300
    ds_read_b128 v[220:223], v247 offset:24576
    v_mfma_f32_16x16x32_bf16 v[188:191], v[228:231], a[200:203], v[188:191]
    ds_read_b128 v[224:227], v248 offset:24576
    ds_read_b128 v[228:231], v247 offset:24704
    v_mfma_f32_16x16x32_bf16 v[168:171], v[88:91], v[140:143], 0
    v_mul_f32 v157, v157, v160
    v_mul_f32 v158, v158, v160
    v_mfma_f32_16x16x32_bf16 v[148:151], v[64:67], v[140:143], 0
    v_mul_f32 v159, v159, v160
    v_cvt_pk_bf16_f32 v156, v156, v157
    v_mfma_f32_16x16x32_bf16 v[152:155], v[72:75], v[140:143], 0
    v_cvt_pk_bf16_f32 v157, v158, v159
    v_mfma_f32_16x16x32_bf16 v[164:167], v[80:83], v[140:143], 0
    ds_read_b128 v[140:143], v250 offset:0
    v_mfma_f32_16x16x32_bf16 v[168:171], v[88:91], v[144:147], v[168:171]
    ds_write_b128 v251, v[132:135] offset:12288
    v_mfma_f32_16x16x32_bf16 v[148:151], v[68:71], v[144:147], v[148:151]
    s_waitcnt lgkmcnt(10)
    ds_read_b128 v[132:135], v250 offset:11264
    v_mfma_f32_16x16x32_bf16 v[152:155], v[76:79], v[144:147], v[152:155]
    s_waitcnt lgkmcnt(6)
    v_cndmask_b32 v136, v254, v136, s[62:63]
    v_mfma_f32_16x16x32_bf16 v[164:167], v[84:87], v[144:147], v[164:167]
    v_rcp_f32 v168, v168
    v_mfma_f32_16x16x32_bf16 v[180:183], v[232:235], a[156:159], v[180:183]
    v_mul_f32 v148, v148, v168
    v_mul_f32 v149, v149, v168
    v_mfma_f32_16x16x32_bf16 v[184:187], v[232:235], a[180:183], v[184:187]
    v_mul_f32 v150, v150, v168
    v_mul_f32 v151, v151, v168
    v_mfma_f32_16x16x32_bf16 v[188:191], v[232:235], a[204:207], v[188:191]
    v_cvt_pk_bf16_f32 v148, v148, v149
    v_mul_f32 v152, v152, v168
    v_mfma_f32_16x16x32_bf16 v[180:183], v[212:215], a[160:163], v[180:183]
    v_mul_f32 v153, v153, v168
    v_mul_f32 v154, v154, v168
    v_mfma_f32_16x16x32_bf16 v[184:187], v[212:215], a[184:187], v[184:187]
    v_mul_f32 v155, v155, v168
    v_cvt_pk_bf16_f32 v149, v150, v151
    v_mfma_f32_16x16x32_bf16 v[188:191], v[212:215], a[208:211], v[188:191]
    ds_read_b128 v[144:147], v250 offset:1024
    v_cvt_pk_bf16_f32 v150, v152, v153
    v_mfma_f32_16x16x32_bf16 v[180:183], v[216:219], a[164:167], v[180:183]
    v_cvt_pk_bf16_f32 v151, v154, v155
    v_mul_f32 v164, v164, v168
    v_mfma_f32_16x16x32_bf16 v[184:187], v[216:219], a[188:191], v[184:187]
    ds_read_b32 v152, v250 offset:12288
    ds_read_b128 v[232:235], v248 offset:24704
    v_mfma_f32_16x16x32_bf16 v[188:191], v[216:219], a[212:215], v[188:191]
    s_waitcnt lgkmcnt(3)
    ds_read_b128 v[212:215], v247 offset:24832
    ds_read_b128 v[216:219], v248 offset:24832
    v_mfma_f32_16x16x32_bf16 v[124:127], v[0:3], v[56:59], v[124:127]
    v_cvt_pk_bf16_f32 v64, v180, v181
    v_cvt_pk_bf16_f32 v65, v182, v183
    v_mfma_f32_16x16x32_bf16 v[128:131], v[8:11], v[56:59], v[128:131]
    v_cvt_pk_bf16_f32 v72, v184, v185
    v_cvt_pk_bf16_f32 v73, v186, v187
    v_mfma_f32_16x16x32_bf16 v[132:135], v[16:19], v[56:59], v[132:135]
    v_mul_f32 v165, v165, v168
    v_mul_f32 v166, v166, v168
    v_mfma_f32_16x16x32_bf16 v[136:139], v[24:27], v[56:59], v[136:139]
    v_mul_f32 v167, v167, v168
    v_cvt_pk_bf16_f32 v164, v164, v165
    v_mfma_f32_16x16x32_bf16 v[124:127], v[4:7], v[60:63], v[124:127]
    ds_write_b128 v251, v[148:151] offset:18432
    v_mfma_f32_16x16x32_bf16 v[128:131], v[12:15], v[60:63], v[128:131]
    ds_read_b128 v[148:151], v250 offset:2048
    v_cvt_pk_bf16_f32 v165, v166, v167
    v_mfma_f32_16x16x32_bf16 v[132:135], v[20:23], v[60:63], v[132:135]
    v_cvt_pk_bf16_f32 v80, v188, v189
    v_cvt_pk_bf16_f32 v81, v190, v191
    v_mfma_f32_16x16x32_bf16 v[136:139], v[28:31], v[60:63], v[136:139]
    s_nop 0
    s_waitcnt lgkmcnt(5)
    v_cndmask_b32 v152, v254, v152, s[62:63]
    v_mfma_f32_16x16x32_bf16 v[192:195], v[220:223], a[144:147], 0
    s_nop 0
    v_mfma_f32_16x16x32_bf16 v[196:199], v[220:223], a[168:171], 0
    s_nop 0
    s_nop 0
    v_max3_f32 v137, v124, v125, v126
    v_mfma_f32_16x16x32_bf16 v[172:175], v[220:223], a[192:195], 0
    ds_read_b128 v[220:223], v249 offset:24576
    v_max3_f32 v138, v127, v128, v129
    v_mfma_f32_16x16x32_bf16 v[192:195], v[224:227], a[148:151], v[192:195]
    v_max3_f32 v137, v137, v130, v131
    v_max3_f32 v138, v138, v132, v133
    v_mfma_f32_16x16x32_bf16 v[196:199], v[224:227], a[172:175], v[196:199]
    v_max3_f32 v137, v137, v134, v135
    v_max3_f32 v137, v137, v138, v136
    v_mfma_f32_16x16x32_bf16 v[172:175], v[224:227], a[196:199], v[172:175]
    ds_read_b128 v[224:227], v249 offset:25600
    v_mov_b32 v138, v137
    v_mfma_f32_16x16x32_bf16 v[192:195], v[228:231], a[152:155], v[192:195]
    s_nop 0
    v_permlane32_swap_b32 v137, v138
    v_mfma_f32_16x16x32_bf16 v[196:199], v[228:231], a[176:179], v[196:199]
    v_max_f32 v137, v137, v138
    v_mov_b32 v138, v137
    v_mfma_f32_16x16x32_bf16 v[172:175], v[228:231], a[200:203], v[172:175]
    s_waitcnt lgkmcnt(2)
    ds_read_b128 v[228:231], v249 offset:26624
    v_mfma_f32_16x16x32_bf16 v[140:143], v[0:3], v[32:35], v[140:143]
    v_permlane16_swap_b32 v137, v138
    v_mfma_f32_16x16x32_bf16 v[144:147], v[8:11], v[32:35], v[144:147]
    v_max_f32 v137, v137, v138
    v_mul_f32 v137, s38, v137
    v_mfma_f32_16x16x32_bf16 v[148:151], v[16:19], v[32:35], v[148:151]
    v_fma_f32 v124, v124, s38, -v137
    v_fma_f32 v125, v125, s38, -v137
    v_mfma_f32_16x16x32_bf16 v[152:155], v[24:27], v[32:35], v[152:155]
    v_fma_f32 v126, v126, s38, -v137
    v_fma_f32 v127, v127, s38, -v137
    v_mfma_f32_16x16x32_bf16 v[140:143], v[4:7], v[36:39], v[140:143]
    v_exp_f32 v124, v124
    v_mfma_f32_16x16x32_bf16 v[144:147], v[12:15], v[36:39], v[144:147]
    v_exp_f32 v125, v125
    v_mfma_f32_16x16x32_bf16 v[148:151], v[20:23], v[36:39], v[148:151]
    v_fma_f32 v128, v128, s38, -v137
    v_fma_f32 v129, v129, s38, -v137
    v_mfma_f32_16x16x32_bf16 v[152:155], v[28:31], v[36:39], v[152:155]
    v_fma_f32 v130, v130, s38, -v137
    v_fma_f32 v131, v131, s38, -v137
    v_mfma_f32_16x16x32_bf16 v[192:195], v[232:235], a[156:159], v[192:195]
    v_exp_f32 v126, v126
    v_mfma_f32_16x16x32_bf16 v[196:199], v[232:235], a[180:183], v[196:199]
    v_exp_f32 v127, v127
    v_mfma_f32_16x16x32_bf16 v[172:175], v[232:235], a[204:207], v[172:175]
    ds_read_b128 v[232:235], v249 offset:27648
    v_cvt_pk_bf16_f32 v124, v124, v125
    v_mfma_f32_16x16x32_bf16 v[192:195], v[212:215], a[160:163], v[192:195]
    v_exp_f32 v128, v128
    v_mfma_f32_16x16x32_bf16 v[196:199], v[212:215], a[184:187], v[196:199]
    v_exp_f32 v129, v129
    v_mfma_f32_16x16x32_bf16 v[172:175], v[212:215], a[208:211], v[172:175]
    ds_read_b128 v[212:215], v249 offset:28672
    v_cvt_pk_bf16_f32 v125, v126, v127
    v_mfma_f32_16x16x32_bf16 v[192:195], v[216:219], a[164:167], v[192:195]
    s_waitcnt lgkmcnt(4)
    v_exp_f32 v130, v130
    v_mfma_f32_16x16x32_bf16 v[196:199], v[216:219], a[188:191], v[196:199]
    v_exp_f32 v131, v131
    v_mfma_f32_16x16x32_bf16 v[172:175], v[216:219], a[212:215], v[172:175]
    ds_read_b128 v[216:219], v249 offset:29696
    v_cvt_pk_bf16_f32 v126, v128, v129
    v_mfma_f32_16x16x32_bf16 v[200:203], a[216:219], v[220:223], 0
    s_waitcnt lgkmcnt(4)
    v_cvt_pk_bf16_f32 v127, v130, v131
    v_fma_f32 v132, v132, s38, -v137
    v_mfma_f32_16x16x32_bf16 v[204:207], a[240:243], v[220:223], 0
    v_fma_f32 v133, v133, s38, -v137
    v_fma_f32 v134, v134, s38, -v137
    v_mfma_f32_16x16x32_bf16 v[208:211], v[100:103], v[220:223], 0
    ds_read_b128 v[220:223], v247 offset:30720
    v_fma_f32 v135, v135, s38, -v137
    v_mfma_f32_16x16x32_bf16 v[200:203], a[220:223], v[224:227], v[200:203]
    s_waitcnt lgkmcnt(4)
    v_exp_f32 v132, v132
    v_mfma_f32_16x16x32_bf16 v[204:207], a[244:247], v[224:227], v[204:207]
    v_exp_f32 v133, v133
    v_mfma_f32_16x16x32_bf16 v[208:211], v[104:107], v[224:227], v[208:211]
    ds_read_b128 v[224:227], v248 offset:30720
    v_cvt_pk_bf16_f32 v66, v192, v193
    v_mfma_f32_16x16x32_bf16 v[200:203], a[224:227], v[228:231], v[200:203]
    s_waitcnt lgkmcnt(4)
    v_exp_f32 v134, v134
    v_mfma_f32_16x16x32_bf16 v[204:207], a[248:251], v[228:231], v[204:207]
    v_exp_f32 v135, v135
    v_mfma_f32_16x16x32_bf16 v[208:211], v[108:111], v[228:231], v[208:211]
    ds_read_b128 v[228:231], v247 offset:30848
    v_cvt_pk_bf16_f32 v67, v194, v195
    v_mfma_f32_16x16x32_bf16 v[200:203], a[228:231], v[232:235], v[200:203]
    s_waitcnt lgkmcnt(4)
    v_fma_f32 v136, v136, s38, -v137
    v_cvt_pk_bf16_f32 v128, v132, v133
    v_mfma_f32_16x16x32_bf16 v[204:207], a[252:255], v[232:235], v[204:207]
    v_cvt_pk_bf16_f32 v129, v134, v135
    v_max3_f32 v153, v140, v141, v142
    v_mfma_f32_16x16x32_bf16 v[208:211], v[112:115], v[232:235], v[208:211]
    ds_read_b128 v[232:235], v248 offset:30848
    v_max3_f32 v154, v143, v144, v145
    v_mfma_f32_16x16x32_bf16 v[200:203], a[232:235], v[212:215], v[200:203]
    s_waitcnt lgkmcnt(4)
    v_exp_f32 v136, v136
    v_mfma_f32_16x16x32_bf16 v[204:207], v[92:95], v[212:215], v[204:207]
    v_cvt_pk_bf16_f32 v74, v196, v197
    v_cvt_pk_bf16_f32 v75, v198, v199
    v_mfma_f32_16x16x32_bf16 v[208:211], v[116:119], v[212:215], v[208:211]
    ds_read_b128 v[212:215], v247 offset:30976
    v_max3_f32 v153, v153, v146, v147
    v_mfma_f32_16x16x32_bf16 v[200:203], a[236:239], v[216:219], v[200:203]
    s_waitcnt lgkmcnt(4)
    v_max3_f32 v154, v154, v148, v149
    v_max3_f32 v153, v153, v150, v151
    v_mfma_f32_16x16x32_bf16 v[204:207], v[96:99], v[216:219], v[204:207]
    v_cvt_pk_bf16_f32 v130, v136, 0
    v_max3_f32 v153, v153, v154, v152
    v_mfma_f32_16x16x32_bf16 v[208:211], v[120:123], v[216:219], v[208:211]
    ds_read_b128 v[216:219], v248 offset:30976
    v_cvt_pk_bf16_f32 v200, v200, v201
    v_mfma_f32_16x16x32_bf16 v[176:179], v[220:223], a[144:147], 0
    s_waitcnt lgkmcnt(4)
    v_cvt_pk_bf16_f32 v201, v202, v203
    v_cvt_pk_bf16_f32 v202, v204, v205
    v_mfma_f32_16x16x32_bf16 v[180:183], v[220:223], a[168:171], 0
    v_cvt_pk_bf16_f32 v203, v206, v207
    v_cvt_pk_bf16_f32 v204, v208, v209
    v_mfma_f32_16x16x32_bf16 v[184:187], v[220:223], a[192:195], 0
    ds_read_b128 v[220:223], v249 offset:30720
    v_cvt_pk_bf16_f32 v205, v210, v211
    v_mfma_f32_16x16x32_bf16 v[176:179], v[224:227], a[148:151], v[176:179]
    s_waitcnt lgkmcnt(4)
    v_mov_b32 v154, v153
    v_cvt_pk_bf16_f32 v82, v172, v173
    v_mfma_f32_16x16x32_bf16 v[180:183], v[224:227], a[172:175], v[180:183]
    v_cvt_pk_bf16_f32 v83, v174, v175
    v_mov_b32 v131, 0
    v_mfma_f32_16x16x32_bf16 v[184:187], v[224:227], a[196:199], v[184:187]
    ds_read_b128 v[224:227], v249 offset:31744
    v_mfma_f32_16x16x32_bf16 v[176:179], v[228:231], a[152:155], v[176:179]
    s_waitcnt lgkmcnt(4)
    v_permlane32_swap_b32 v153, v154
    v_mfma_f32_16x16x32_bf16 v[180:183], v[228:231], a[176:179], v[180:183]
    v_max_f32 v153, v153, v154
    v_mov_b32 v154, v153
    v_mfma_f32_16x16x32_bf16 v[184:187], v[228:231], a[200:203], v[184:187]
    ds_read_b128 v[228:231], v249 offset:32768
    v_mfma_f32_16x16x32_bf16 v[176:179], v[232:235], a[156:159], v[176:179]
    s_waitcnt lgkmcnt(4)
    v_permlane16_swap_b32 v153, v154
    v_mfma_f32_16x16x32_bf16 v[180:183], v[232:235], a[180:183], v[180:183]
    v_max_f32 v153, v153, v154
    v_mul_f32 v153, s38, v153
    v_mfma_f32_16x16x32_bf16 v[184:187], v[232:235], a[204:207], v[184:187]
    buffer_store_dwordx4 v[200:203], v241, s[32:35], s42 offen sc0 sc1
    v_mfma_f32_16x16x32_bf16 v[176:179], v[212:215], a[160:163], v[176:179]
    s_waitcnt lgkmcnt(3)
    ds_write_b64 v246, v[204:205] offset:6144
    v_mfma_f32_16x16x32_bf16 v[180:183], v[212:215], a[184:187], v[180:183]
    ds_read_b128 v[232:235], v249 offset:33792
    v_fma_f32 v140, v140, s38, -v153
    v_mfma_f32_16x16x32_bf16 v[184:187], v[212:215], a[208:211], v[184:187]
    ds_read_b128 v[212:215], v249 offset:34816
    v_fma_f32 v141, v141, s38, -v153
    v_mfma_f32_16x16x32_bf16 v[176:179], v[216:219], a[164:167], v[176:179]
    s_waitcnt lgkmcnt(5)
    v_fma_f32 v142, v142, s38, -v153
    v_fma_f32 v143, v143, s38, -v153
    v_mfma_f32_16x16x32_bf16 v[180:183], v[216:219], a[188:191], v[180:183]
    v_exp_f32 v140, v140
    v_mfma_f32_16x16x32_bf16 v[184:187], v[216:219], a[212:215], v[184:187]
    s_nop 0
    ds_read_b128 v[216:219], v249 offset:35840
    v_cvt_pk_bf16_f32 v68, v176, v177
    v_mfma_f32_16x16x32_bf16 v[200:203], a[216:219], v[220:223], 0
    s_waitcnt lgkmcnt(5)
    v_cvt_pk_bf16_f32 v69, v178, v179
    v_cvt_pk_bf16_f32 v76, v180, v181
    v_mfma_f32_16x16x32_bf16 v[204:207], a[240:243], v[220:223], 0
    v_cvt_pk_bf16_f32 v77, v182, v183
    v_fma_f32 v144, v144, s38, -v153
    v_mfma_f32_16x16x32_bf16 v[208:211], v[100:103], v[220:223], 0
    ds_read_b128 v[220:223], v249 offset:36864
    v_fma_f32 v145, v145, s38, -v153
    v_mfma_f32_16x16x32_bf16 v[200:203], a[220:223], v[224:227], v[200:203]
    s_waitcnt lgkmcnt(5)
    v_exp_f32 v141, v141
    v_mfma_f32_16x16x32_bf16 v[204:207], a[244:247], v[224:227], v[204:207]
    v_fma_f32 v146, v146, s38, -v153
    v_fma_f32 v147, v147, s38, -v153
    v_mfma_f32_16x16x32_bf16 v[208:211], v[104:107], v[224:227], v[208:211]
    ds_read_b128 v[224:227], v249 offset:37888
    v_cvt_pk_bf16_f32 v84, v184, v185
    v_mfma_f32_16x16x32_bf16 v[200:203], a[224:227], v[228:231], v[200:203]
    s_waitcnt lgkmcnt(4)
    v_exp_f32 v142, v142
    v_mfma_f32_16x16x32_bf16 v[204:207], a[248:251], v[228:231], v[204:207]
    v_exp_f32 v143, v143
    v_mfma_f32_16x16x32_bf16 v[208:211], v[108:111], v[228:231], v[208:211]
    ds_write_b64 v252, v[156:157] offset:12288
    ds_write_b64 v252, v[164:165] offset:18432
    v_mfma_f32_16x16x32_bf16 v[200:203], a[228:231], v[232:235], v[200:203]
    s_waitcnt lgkmcnt(5)
    ds_read_b128 v[228:231], v249 offset:38912
    v_cvt_pk_bf16_f32 v85, v186, v187
    v_mfma_f32_16x16x32_bf16 v[204:207], a[252:255], v[232:235], v[204:207]
    v_exp_f32 v144, v144
    v_mfma_f32_16x16x32_bf16 v[208:211], v[112:115], v[232:235], v[208:211]
    ds_read_b128 v[232:235], v249 offset:39936
    v_cvt_pk_bf16_f32 v140, v140, v141
    v_mfma_f32_16x16x32_bf16 v[200:203], a[232:235], v[212:215], v[200:203]
    s_waitcnt lgkmcnt(6)
    v_exp_f32 v145, v145
    v_mfma_f32_16x16x32_bf16 v[204:207], v[92:95], v[212:215], v[204:207]
    v_exp_f32 v146, v146
    v_mfma_f32_16x16x32_bf16 v[208:211], v[116:119], v[212:215], v[208:211]
    ds_read_b128 v[212:215], v249 offset:40960
    v_cvt_pk_bf16_f32 v141, v142, v143
    v_mfma_f32_16x16x32_bf16 v[200:203], a[236:239], v[216:219], v[200:203]
    v_exp_f32 v147, v147
    s_nop 0
    v_mfma_f32_16x16x32_bf16 v[204:207], v[96:99], v[216:219], v[204:207]
    s_nop 0
    v_cvt_pk_bf16_f32 v142, v144, v145
    v_cvt_pk_bf16_f32 v143, v146, v147
    v_mfma_f32_16x16x32_bf16 v[208:211], v[120:123], v[216:219], v[208:211]
    s_nop 0
    v_cvt_pk_bf16_f32 v200, v200, v201
    v_cvt_pk_bf16_f32 v201, v202, v203
    v_mfma_f32_16x16x32_bf16 v[160:163], v[88:91], v[124:127], 0
    v_cvt_pk_bf16_f32 v202, v204, v205
    v_cvt_pk_bf16_f32 v203, v206, v207
    v_mfma_f32_16x16x32_bf16 v[132:135], v[64:67], v[124:127], 0
    buffer_store_dwordx4 v[200:203], v242, s[32:35], s42 offen sc0 sc1
    s_waitcnt lgkmcnt(6)
    s_nop 0
    v_mfma_f32_16x16x32_bf16 v[200:203], a[216:219], v[220:223], 0
    s_waitcnt lgkmcnt(5)
    v_cvt_pk_bf16_f32 v204, v208, v209
    v_cvt_pk_bf16_f32 v205, v210, v211
    v_mfma_f32_16x16x32_bf16 v[208:211], v[100:103], v[220:223], 0
    ds_write_b64 v246, v[204:205] offset:8192
    v_mfma_f32_16x16x32_bf16 v[204:207], a[240:243], v[220:223], 0
    ds_read_b128 v[216:219], v249 offset:41984
    v_fma_f32 v148, v148, s38, -v153
    v_mfma_f32_16x16x32_bf16 v[200:203], a[220:223], v[224:227], v[200:203]
    s_waitcnt lgkmcnt(4)
    v_fma_f32 v149, v149, s38, -v153
    v_fma_f32 v150, v150, s38, -v153
    v_mfma_f32_16x16x32_bf16 v[204:207], a[244:247], v[224:227], v[204:207]
    v_fma_f32 v151, v151, s38, -v153
    v_fma_f32 v152, v152, s38, -v153
    v_mfma_f32_16x16x32_bf16 v[208:211], v[104:107], v[224:227], v[208:211]
    v_exp_f32 v148, v148
    v_mfma_f32_16x16x32_bf16 v[200:203], a[224:227], v[228:231], v[200:203]
    s_waitcnt lgkmcnt(3)
    v_exp_f32 v149, v149
    v_mfma_f32_16x16x32_bf16 v[204:207], a[248:251], v[228:231], v[204:207]
    v_exp_f32 v150, v150
    v_mfma_f32_16x16x32_bf16 v[208:211], v[108:111], v[228:231], v[208:211]
    v_exp_f32 v151, v151
    v_mfma_f32_16x16x32_bf16 v[200:203], a[228:231], v[232:235], v[200:203]
    s_waitcnt lgkmcnt(2)
    v_cvt_pk_bf16_f32 v144, v148, v149
    v_cvt_pk_bf16_f32 v145, v150, v151
    v_mfma_f32_16x16x32_bf16 v[204:207], a[252:255], v[232:235], v[204:207]
    v_exp_f32 v152, v152
    v_mfma_f32_16x16x32_bf16 v[208:211], v[112:115], v[232:235], v[208:211]
    v_cvt_pk_bf16_f32 v146, v152, 0
    v_mov_b32 v147, 0
    v_mfma_f32_16x16x32_bf16 v[200:203], a[232:235], v[212:215], v[200:203]
    s_waitcnt lgkmcnt(0)
    v_mfma_f32_16x16x32_bf16 v[204:207], v[92:95], v[212:215], v[204:207]
    v_mfma_f32_16x16x32_bf16 v[208:211], v[116:119], v[212:215], v[208:211]
    v_mfma_f32_16x16x32_bf16 v[200:203], a[236:239], v[216:219], v[200:203]
    s_nop 0
    v_mfma_f32_16x16x32_bf16 v[204:207], v[96:99], v[216:219], v[204:207]
    s_nop 0
    v_mfma_f32_16x16x32_bf16 v[208:211], v[120:123], v[216:219], v[208:211]
    s_nop 0
    v_mfma_f32_16x16x32_bf16 v[136:139], v[72:75], v[124:127], 0
    s_nop 0
    s_nop 0
    v_cvt_pk_bf16_f32 v200, v200, v201
    v_mfma_f32_16x16x32_bf16 v[156:159], v[80:83], v[124:127], 0
    v_cvt_pk_bf16_f32 v201, v202, v203
    v_cvt_pk_bf16_f32 v202, v204, v205
    v_mfma_f32_16x16x32_bf16 v[160:163], v[88:91], v[128:131], v[160:163]
    v_cvt_pk_bf16_f32 v204, v208, v209
    v_cvt_pk_bf16_f32 v205, v210, v211
    v_mfma_f32_16x16x32_bf16 v[132:135], v[68:71], v[128:131], v[132:135]
    ds_write_b64 v246, v[204:205] offset:10240
    v_mfma_f32_16x16x32_bf16 v[136:139], v[76:79], v[128:131], v[136:139]
    v_cvt_pk_bf16_f32 v203, v206, v207
    v_mfma_f32_16x16x32_bf16 v[156:159], v[84:87], v[128:131], v[156:159]
    s_nop 0
    v_rcp_f32 v160, v160
    v_mfma_f32_16x16x32_bf16 v[168:171], v[88:91], v[140:143], 0
    ds_read_b128 v[124:127], v250 offset:3072
    v_mul_f32 v132, v132, v160
    v_mfma_f32_16x16x32_bf16 v[148:151], v[64:67], v[140:143], 0
    buffer_store_dwordx4 v[200:203], v243, s[32:35], s42 offen sc0 sc1
    v_mfma_f32_16x16x32_bf16 v[152:155], v[72:75], v[140:143], 0
    v_mul_f32 v133, v133, v160
    v_mul_f32 v134, v134, v160
    v_mfma_f32_16x16x32_bf16 v[164:167], v[80:83], v[140:143], 0
    v_mul_f32 v135, v135, v160
    v_cvt_pk_bf16_f32 v132, v132, v133
    v_mfma_f32_16x16x32_bf16 v[168:171], v[88:91], v[144:147], v[168:171]
    v_mul_f32 v136, v136, v160
    v_mul_f32 v137, v137, v160
    v_mfma_f32_16x16x32_bf16 v[148:151], v[68:71], v[144:147], v[148:151]
    v_mul_f32 v138, v138, v160
    v_mul_f32 v139, v139, v160
    v_mfma_f32_16x16x32_bf16 v[152:155], v[76:79], v[144:147], v[152:155]
    s_waitcnt lgkmcnt(1)
    s_barrier
    v_mfma_f32_16x16x32_bf16 v[164:167], v[84:87], v[144:147], v[164:167]
    ds_read_b128 v[228:231], v249 offset:6144
    s_waitcnt lgkmcnt(1)
    v_mfma_f32_16x16x32_bf16 v[124:127], v[0:3], v[40:43], v[124:127]
    ds_read_b128 v[232:235], v249 offset:7168
    ds_read_b128 v[220:223], v236 offset:6144
    v_mfma_f32_16x16x32_bf16 v[124:127], v[4:7], v[44:47], v[124:127]
    ds_read_b128 v[212:215], v249 offset:8192
    ds_read_b128 v[224:227], v236 offset:7168
    ds_read_b128 v[216:219], v249 offset:9216
    v_cvt_pk_bf16_f32 v133, v134, v135
    v_cvt_pk_bf16_f32 v134, v136, v137
    v_cvt_pk_bf16_f32 v135, v138, v139
    ds_read_b128 v[128:131], v250 offset:4096
    s_mov_b64 exec, s[70:71]
    ds_write_b128 v251, v[132:135] offset:0
    s_mov_b64 exec, -1
    ds_read_b128 v[132:135], v250 offset:5120
    ds_read_b32 v136, v250 offset:12292
    v_rcp_f32 v168, v168
    v_mul_f32 v156, v156, v160
    v_mul_f32 v148, v148, v168
    v_mul_f32 v149, v149, v168
    v_mul_f32 v150, v150, v168
    v_mul_f32 v151, v151, v168
    s_waitcnt lgkmcnt(9)
    v_mfma_f32_16x16x32_bf16 v[200:203], a[216:219], v[228:231], 0
    ds_read_b128 v[140:143], v250 offset:6144
    v_cvt_pk_bf16_f32 v148, v148, v149
    v_mfma_f32_16x16x32_bf16 v[204:207], a[240:243], v[228:231], 0
    s_waitcnt lgkmcnt(9)
    v_mul_f32 v152, v152, v168
    v_mul_f32 v153, v153, v168
    v_mfma_f32_16x16x32_bf16 v[208:211], v[100:103], v[228:231], 0
    s_waitcnt lgkmcnt(8)
    buffer_store_dwordx4 v[220:223], v244, s[32:35], s42 offen sc0 sc1
    v_mfma_f32_16x16x32_bf16 v[200:203], a[220:223], v[232:235], v[200:203]
    s_waitcnt lgkmcnt(6)
    ds_read_b128 v[220:223], v249 offset:10240
    v_mfma_f32_16x16x32_bf16 v[204:207], a[244:247], v[232:235], v[204:207]
    s_mov_b64 exec, s[54:55]
    buffer_store_dwordx4 v[224:227], v245, s[32:35], s42 offen sc0 sc1
    s_mov_b64 exec, -1
    v_mfma_f32_16x16x32_bf16 v[208:211], v[104:107], v[232:235], v[208:211]
    s_nop 0
    ds_read_b128 v[224:227], v249 offset:11264
    v_mul_f32 v154, v154, v168
    v_mfma_f32_16x16x32_bf16 v[200:203], a[224:227], v[212:215], v[200:203]
    s_waitcnt lgkmcnt(7)
    v_mul_f32 v155, v155, v168
    v_cvt_pk_bf16_f32 v149, v150, v151
    v_mfma_f32_16x16x32_bf16 v[204:207], a[248:251], v[212:215], v[204:207]
    ds_read_b128 v[144:147], v250 offset:7168
    v_cvt_pk_bf16_f32 v150, v152, v153
    v_mfma_f32_16x16x32_bf16 v[208:211], v[108:111], v[212:215], v[208:211]
    v_cvt_pk_bf16_f32 v151, v154, v155
    v_mul_f32 v157, v157, v160
    v_mfma_f32_16x16x32_bf16 v[200:203], a[228:231], v[216:219], v[200:203]
    ds_read_b32 v152, v250 offset:12296
    ds_read_b128 v[228:231], v249 offset:12288
    v_mfma_f32_16x16x32_bf16 v[204:207], a[252:255], v[216:219], v[204:207]
    ds_read_b128 v[232:235], v249 offset:13312
    ds_read_b128 v[212:215], v249 offset:14336
    v_mfma_f32_16x16x32_bf16 v[208:211], v[112:115], v[216:219], v[208:211]
    ds_read_b128 v[216:219], v249 offset:15360
    s_waitcnt lgkmcnt(12)
    v_mfma_f32_16x16x32_bf16 v[128:131], v[8:11], v[40:43], v[128:131]
    v_mul_f32 v164, v164, v168
    v_mul_f32 v165, v165, v168
    v_mfma_f32_16x16x32_bf16 v[128:131], v[12:15], v[44:47], v[128:131]
    s_waitcnt lgkmcnt(7)
    v_cndmask_b32 v136, v254, v136, s[62:63]
    v_mul_f32 v158, v158, v160
    v_mfma_f32_16x16x32_bf16 v[200:203], a[232:235], v[220:223], v[200:203]
    s_waitcnt lgkmcnt(6)
    v_mul_f32 v159, v159, v160
    v_mul_f32 v166, v166, v168
    v_mfma_f32_16x16x32_bf16 v[204:207], v[92:95], v[220:223], v[204:207]
    ds_write_b128 v251, v[148:151] offset:24576
    v_mfma_f32_16x16x32_bf16 v[208:211], v[116:119], v[220:223], v[208:211]
    ds_read_b128 v[148:151], v250 offset:8192
    ds_read_b128 v[220:223], v249 offset:16384
    v_mfma_f32_16x16x32_bf16 v[200:203], a[236:239], v[224:227], v[200:203]
    v_mul_f32 v167, v167, v168
    v_cvt_pk_bf16_f32 v156, v156, v157
    v_mfma_f32_16x16x32_bf16 v[204:207], v[96:99], v[224:227], v[204:207]
    v_cvt_pk_bf16_f32 v164, v164, v165
    v_cvt_pk_bf16_f32 v157, v158, v159
    v_mfma_f32_16x16x32_bf16 v[208:211], v[120:123], v[224:227], v[208:211]
    ds_read_b128 v[224:227], v249 offset:17408
    v_cvt_pk_bf16_f32 v165, v166, v167
    v_mfma_f32_16x16x32_bf16 v[132:135], v[16:19], v[40:43], v[132:135]
    v_cvt_pk_bf16_f32 v200, v200, v201
    v_cvt_pk_bf16_f32 v201, v202, v203
    v_mfma_f32_16x16x32_bf16 v[136:139], v[24:27], v[40:43], v[136:139]
    v_cvt_pk_bf16_f32 v202, v204, v205
    v_cvt_pk_bf16_f32 v203, v206, v207
    v_mfma_f32_16x16x32_bf16 v[132:135], v[20:23], v[44:47], v[132:135]
    s_waitcnt lgkmcnt(8)
    v_cndmask_b32 v152, v254, v152, s[62:63]
    v_cvt_pk_bf16_f32 v204, v208, v209
    v_mfma_f32_16x16x32_bf16 v[136:139], v[28:31], v[44:47], v[136:139]
    s_nop 0
    v_cvt_pk_bf16_f32 v205, v210, v211
    v_mov_b32 v254, s74
    v_mfma_f32_16x16x32_bf16 v[140:143], v[0:3], v[48:51], v[140:143]
    s_nop 0
    v_mfma_f32_16x16x32_bf16 v[144:147], v[8:11], v[48:51], v[144:147]
    s_nop 0
    s_nop 0
    v_max3_f32 v137, v124, v125, v126
    v_mfma_f32_16x16x32_bf16 v[152:155], v[24:27], v[48:51], v[152:155]
    s_waitcnt lgkmcnt(2)
    v_max3_f32 v138, v127, v128, v129
    v_max3_f32 v137, v137, v130, v131
    v_mfma_f32_16x16x32_bf16 v[148:151], v[16:19], v[48:51], v[148:151]
    v_max3_f32 v138, v138, v132, v133
    v_max3_f32 v137, v137, v134, v135
    v_mfma_f32_16x16x32_bf16 v[140:143], v[4:7], v[52:55], v[140:143]
    v_max3_f32 v137, v137, v138, v136
    v_mov_b32 v138, v137
    v_mfma_f32_16x16x32_bf16 v[144:147], v[12:15], v[52:55], v[144:147]
    s_nop 0
    v_permlane32_swap_b32 v137, v138
    v_mfma_f32_16x16x32_bf16 v[148:151], v[20:23], v[52:55], v[148:151]
    v_max_f32 v137, v137, v138
    v_mov_b32 v138, v137
    v_mfma_f32_16x16x32_bf16 v[152:155], v[28:31], v[52:55], v[152:155]
    s_nop 0
    v_permlane16_swap_b32 v137, v138
    v_mfma_f32_16x16x32_bf16 v[172:175], a[216:219], v[228:231], 0
    v_max_f32 v137, v137, v138
    v_mul_f32 v137, s38, v137
    v_mfma_f32_16x16x32_bf16 v[176:179], a[240:243], v[228:231], 0
    v_fma_f32 v124, v124, s38, -v137
    v_fma_f32 v125, v125, s38, -v137
    v_mfma_f32_16x16x32_bf16 v[180:183], v[100:103], v[228:231], 0
    ds_read_b128 v[228:231], v249 offset:18432
    v_fma_f32 v126, v126, s38, -v137
    v_mfma_f32_16x16x32_bf16 v[172:175], a[220:223], v[232:235], v[172:175]
    v_fma_f32 v127, v127, s38, -v137
    v_fma_f32 v128, v128, s38, -v137
    v_mfma_f32_16x16x32_bf16 v[176:179], a[244:247], v[232:235], v[176:179]
    v_exp_f32 v124, v124
    v_mfma_f32_16x16x32_bf16 v[180:183], v[104:107], v[232:235], v[180:183]
    ds_read_b128 v[232:235], v249 offset:19456
    v_fma_f32 v129, v129, s38, -v137
    v_mfma_f32_16x16x32_bf16 v[172:175], a[224:227], v[212:215], v[172:175]
    v_exp_f32 v125, v125
    v_mfma_f32_16x16x32_bf16 v[176:179], a[248:251], v[212:215], v[176:179]
    v_fma_f32 v130, v130, s38, -v137
    v_fma_f32 v131, v131, s38, -v137
    v_mfma_f32_16x16x32_bf16 v[180:183], v[108:111], v[212:215], v[180:183]
    ds_read_b128 v[212:215], v249 offset:20480
    v_cvt_pk_bf16_f32 v124, v124, v125
    v_mfma_f32_16x16x32_bf16 v[172:175], a[228:231], v[216:219], v[172:175]
    s_waitcnt lgkmcnt(4)
    v_exp_f32 v126, v126
    v_mfma_f32_16x16x32_bf16 v[176:179], a[252:255], v[216:219], v[176:179]
    v_exp_f32 v127, v127
    v_mfma_f32_16x16x32_bf16 v[180:183], v[112:115], v[216:219], v[180:183]
    s_mov_b64 exec, s[70:71]
    ds_write_b64 v252, v[156:157] offset:0
    s_mov_b64 exec, -1
    ds_write_b64 v252, v[164:165] offset:24576
    v_mfma_f32_16x16x32_bf16 v[172:175], a[232:235], v[220:223], v[172:175]
    s_waitcnt lgkmcnt(5)
L_pad6:
    s_cbranch_execz L_ret6
    ds_read_b128 v[216:219], v249 offset:21504
    v_cvt_pk_bf16_f32 v125, v126, v127
    v_mfma_f32_16x16x32_bf16 v[176:179], v[92:95], v[220:223], v[176:179]
    v_exp_f32 v128, v128
    v_mfma_f32_16x16x32_bf16 v[180:183], v[116:119], v[220:223], v[180:183]
    ds_read_b128 v[220:223], v249 offset:22528
    v_fma_f32 v132, v132, s38, -v137
    v_mfma_f32_16x16x32_bf16 v[172:175], a[236:239], v[224:227], v[172:175]
    s_waitcnt lgkmcnt(6)
    v_exp_f32 v129, v129
    v_mfma_f32_16x16x32_bf16 v[176:179], v[96:99], v[224:227], v[176:179]
    v_exp_f32 v130, v130
    v_mfma_f32_16x16x32_bf16 v[180:183], v[120:123], v[224:227], v[180:183]
    ds_read_b128 v[224:227], v249 offset:23552
    v_fma_f32 v133, v133, s38, -v137
    v_mfma_f32_16x16x32_bf16 v[184:187], a[216:219], v[228:231], 0
    s_waitcnt lgkmcnt(6)
    v_exp_f32 v131, v131
    v_mfma_f32_16x16x32_bf16 v[188:191], a[240:243], v[228:231], 0
    v_fma_f32 v134, v134, s38, -v137
    v_fma_f32 v135, v135, s38, -v137
    v_mfma_f32_16x16x32_bf16 v[192:195], v[100:103], v[228:231], 0
    v_fma_f32 v136, v136, s38, -v137
    v_cvt_pk_bf16_f32 v126, v128, v129
    v_mfma_f32_16x16x32_bf16 v[184:187], a[220:223], v[232:235], v[184:187]
    s_waitcnt lgkmcnt(5)
    v_cvt_pk_bf16_f32 v127, v130, v131
    v_mov_b32 v131, 0
    v_mfma_f32_16x16x32_bf16 v[188:191], a[244:247], v[232:235], v[188:191]
    v_cvt_pk_bf16_f32 v172, v172, v173
    v_cvt_pk_bf16_f32 v173, v174, v175
    v_mfma_f32_16x16x32_bf16 v[192:195], v[104:107], v[232:235], v[192:195]
    s_waitcnt lgkmcnt(3)
    s_barrier
    ds_read_b128 v[228:231], v249 offset:24576
    v_mfma_f32_16x16x32_bf16 v[184:187], a[224:227], v[212:215], v[184:187]
    s_waitcnt lgkmcnt(3)
    ds_read_b128 v[232:235], v249 offset:25600
    v_cvt_pk_bf16_f32 v174, v176, v177
    v_mfma_f32_16x16x32_bf16 v[188:191], a[248:251], v[212:215], v[188:191]
    v_exp_f32 v132, v132
    v_mfma_f32_16x16x32_bf16 v[192:195], v[108:111], v[212:215], v[192:195]
    ds_read_b128 v[212:215], v249 offset:26624
    v_cvt_pk_bf16_f32 v176, v180, v181
    v_mfma_f32_16x16x32_bf16 v[184:187], a[228:231], v[216:219], v[184:187]
    s_waitcnt lgkmcnt(4)
    v_exp_f32 v133, v133
    v_mfma_f32_16x16x32_bf16 v[188:191], a[252:255], v[216:219], v[188:191]
    v_exp_f32 v134, v134
    v_mfma_f32_16x16x32_bf16 v[192:195], v[112:115], v[216:219], v[192:195]
    buffer_store_dwordx4 v[200:203], v241, s[32:35], s43 offen sc0 sc1
    v_mfma_f32_16x16x32_bf16 v[184:187], a[232:235], v[220:223], v[184:187]
    s_waitcnt lgkmcnt(3)
    ds_write_b64 v246, v[204:205] offset:0
    v_mfma_f32_16x16x32_bf16 v[188:191], v[92:95], v[220:223], v[188:191]
    ds_read_b128 v[216:219], v249 offset:27648
    v_cvt_pk_bf16_f32 v128, v132, v133
    v_mfma_f32_16x16x32_bf16 v[192:195], v[116:119], v[220:223], v[192:195]
    ds_read_b128 v[220:223], v249 offset:28672
    v_cvt_pk_bf16_f32 v177, v182, v183
    v_mfma_f32_16x16x32_bf16 v[184:187], a[236:239], v[224:227], v[184:187]
    s_waitcnt lgkmcnt(5)
    v_exp_f32 v135, v135
    v_mfma_f32_16x16x32_bf16 v[188:191], v[96:99], v[224:227], v[188:191]
    v_exp_f32 v136, v136
    v_mfma_f32_16x16x32_bf16 v[192:195], v[120:123], v[224:227], v[192:195]
    v_cvt_pk_bf16_f32 v129, v134, v135
    v_cvt_pk_bf16_f32 v130, v136, 0
    v_mfma_f32_16x16x32_bf16 v[200:203], a[216:219], v[228:231], 0
    s_waitcnt lgkmcnt(4)
    ds_read_b128 v[224:227], v249 offset:29696
    v_cvt_pk_bf16_f32 v184, v184, v185
    v_mfma_f32_16x16x32_bf16 v[204:207], a[240:243], v[228:231], 0
    v_cvt_pk_bf16_f32 v185, v186, v187
    v_cvt_pk_bf16_f32 v186, v188, v189
    v_mfma_f32_16x16x32_bf16 v[208:211], v[100:103], v[228:231], 0
    v_cvt_pk_bf16_f32 v188, v192, v193
    v_cvt_pk_bf16_f32 v189, v194, v195
    v_mfma_f32_16x16x32_bf16 v[200:203], a[220:223], v[232:235], v[200:203]
    s_waitcnt lgkmcnt(4)
    v_cvt_pk_bf16_f32 v175, v178, v179
    v_max3_f32 v153, v140, v141, v142
    v_mfma_f32_16x16x32_bf16 v[204:207], a[244:247], v[232:235], v[204:207]
    ds_write_b64 v246, v[176:177] offset:2048
    ds_write_b64 v246, v[188:189] offset:4096
    v_mfma_f32_16x16x32_bf16 v[208:211], v[104:107], v[232:235], v[208:211]
    v_max3_f32 v154, v143, v144, v145
    v_max3_f32 v153, v153, v146, v147
    v_mfma_f32_16x16x32_bf16 v[200:203], a[224:227], v[212:215], v[200:203]
    s_waitcnt lgkmcnt(4)
    v_max3_f32 v154, v154, v148, v149
    v_max3_f32 v153, v153, v150, v151
    v_mfma_f32_16x16x32_bf16 v[204:207], a[248:251], v[212:215], v[204:207]
    v_max3_f32 v153, v153, v154, v152
    v_mov_b32 v154, v153
    v_mfma_f32_16x16x32_bf16 v[208:211], v[108:111], v[212:215], v[208:211]
    ds_read_b128 v[212:215], v249 offset:0
    v_cvt_pk_bf16_f32 v187, v190, v191
    v_mfma_f32_16x16x32_bf16 v[200:203], a[228:231], v[216:219], v[200:203]
    s_waitcnt lgkmcnt(4)
    v_permlane32_swap_b32 v153, v154
    v_mfma_f32_16x16x32_bf16 v[204:207], a[252:255], v[216:219], v[204:207]
    v_max_f32 v153, v153, v154
    v_mov_b32 v154, v153
    v_mfma_f32_16x16x32_bf16 v[208:211], v[112:115], v[216:219], v[208:211]
    ds_read_b128 v[216:219], v249 offset:1024
    v_add_u32 v241, v241, v255
    v_mfma_f32_16x16x32_bf16 v[200:203], a[232:235], v[220:223], v[200:203]
    s_waitcnt lgkmcnt(4)
    v_permlane16_swap_b32 v153, v154
    v_mfma_f32_16x16x32_bf16 v[204:207], v[92:95], v[220:223], v[204:207]
    v_max_f32 v153, v153, v154
    v_mul_f32 v153, s38, v153
    v_mfma_f32_16x16x32_bf16 v[208:211], v[116:119], v[220:223], v[208:211]
    ds_read_b128 v[220:223], v249 offset:2048
    v_fma_f32 v140, v140, s38, -v153
    v_mfma_f32_16x16x32_bf16 v[200:203], a[236:239], v[224:227], v[200:203]
    v_fma_f32 v141, v141, s38, -v153
    v_fma_f32 v142, v142, s38, -v153
    v_mfma_f32_16x16x32_bf16 v[204:207], v[96:99], v[224:227], v[204:207]
    v_fma_f32 v143, v143, s38, -v153
    v_fma_f32 v144, v144, s38, -v153
    v_mfma_f32_16x16x32_bf16 v[208:211], v[120:123], v[224:227], v[208:211]
    ds_read_b128 v[224:227], v249 offset:3072
    v_fma_f32 v145, v145, s38, -v153
    v_mfma_f32_16x16x32_bf16 v[160:163], v[88:91], v[124:127], 0
    v_exp_f32 v140, v140
    v_mfma_f32_16x16x32_bf16 v[132:135], v[64:67], v[124:127], 0
    buffer_store_dwordx4 v[172:175], v242, s[32:35], s43 offen sc0 sc1
    v_mfma_f32_16x16x32_bf16 v[136:139], v[72:75], v[124:127], 0
    v_exp_f32 v141, v141
    v_mfma_f32_16x16x32_bf16 v[156:159], v[80:83], v[124:127], 0
    v_fma_f32 v146, v146, s38, -v153
    v_fma_f32 v147, v147, s38, -v153
    v_mfma_f32_16x16x32_bf16 v[160:163], v[88:91], v[128:131], v[160:163]
    v_exp_f32 v142, v142
    s_nop 0
    v_mfma_f32_16x16x32_bf16 v[132:135], v[68:71], v[128:131], v[132:135]
    s_waitcnt lgkmcnt(3)
    v_exp_f32 v143, v143
    s_nop 0
    v_mfma_f32_16x16x32_bf16 v[136:139], v[76:79], v[128:131], v[136:139]
    s_nop 0
    v_rcp_f32 v160, v160
    v_mfma_f32_16x16x32_bf16 v[156:159], v[84:87], v[128:131], v[156:159]
    s_nop 0
    v_mul_f32 v132, v132, v160
    v_mul_f32 v133, v133, v160
    v_mfma_f32_16x16x32_bf16 v[172:175], a[216:219], v[212:215], 0
    s_waitcnt lgkmcnt(2)
    v_mul_f32 v134, v134, v160
    v_mul_f32 v135, v135, v160
    v_mfma_f32_16x16x32_bf16 v[176:179], a[240:243], v[212:215], 0
    v_mul_f32 v156, v156, v160
    v_mul_f32 v157, v157, v160
    v_mfma_f32_16x16x32_bf16 v[180:183], v[100:103], v[212:215], 0
    v_cvt_pk_bf16_f32 v132, v132, v133
    v_mul_f32 v136, v136, v160
    v_mfma_f32_16x16x32_bf16 v[172:175], a[220:223], v[216:219], v[172:175]
    s_waitcnt lgkmcnt(1)
    v_mul_f32 v137, v137, v160
    v_mul_f32 v138, v138, v160
    v_mfma_f32_16x16x32_bf16 v[176:179], a[244:247], v[216:219], v[176:179]
    v_mul_f32 v139, v139, v160
    v_mul_f32 v158, v158, v160
    v_mfma_f32_16x16x32_bf16 v[180:183], v[104:107], v[216:219], v[180:183]
    v_mul_f32 v159, v159, v160
    v_cvt_pk_bf16_f32 v156, v156, v157
    v_mfma_f32_16x16x32_bf16 v[172:175], a[224:227], v[220:223], v[172:175]
    s_waitcnt lgkmcnt(0)
    v_cvt_pk_bf16_f32 v133, v134, v135
    v_cvt_pk_bf16_f32 v157, v158, v159
    v_mfma_f32_16x16x32_bf16 v[176:179], a[248:251], v[220:223], v[176:179]
    v_cvt_pk_bf16_f32 v134, v136, v137
    v_cvt_pk_bf16_f32 v135, v138, v139
    v_mfma_f32_16x16x32_bf16 v[180:183], v[108:111], v[220:223], v[180:183]
    ds_write_b64 v252, v[156:157] offset:30720
    ds_write_b128 v251, v[132:135] offset:30720
    v_mfma_f32_16x16x32_bf16 v[172:175], a[228:231], v[224:227], v[172:175]
    v_exp_f32 v144, v144
    v_mfma_f32_16x16x32_bf16 v[176:179], a[252:255], v[224:227], v[176:179]
    v_exp_f32 v145, v145
    v_mfma_f32_16x16x32_bf16 v[180:183], v[112:115], v[224:227], v[180:183]
    v_exp_f32 v146, v146
    v_exp_f32 v147, v147
    v_cvt_pk_bf16_f32 v140, v140, v141
    v_cvt_pk_bf16_f32 v141, v142, v143
    v_cvt_pk_bf16_f32 v142, v144, v145
    v_cvt_pk_bf16_f32 v143, v146, v147
    v_fma_f32 v148, v148, s38, -v153
    v_fma_f32 v149, v149, s38, -v153
    v_mfma_f32_16x16x32_bf16 v[168:171], v[88:91], v[140:143], 0
    v_fma_f32 v150, v150, s38, -v153
    v_fma_f32 v151, v151, s38, -v153
    v_mfma_f32_16x16x32_bf16 v[164:167], v[80:83], v[140:143], 0
    v_exp_f32 v148, v148
    v_exp_f32 v149, v149
    v_exp_f32 v150, v150
    v_exp_f32 v151, v151
    v_fma_f32 v152, v152, s38, -v153
    v_cvt_pk_bf16_f32 v144, v148, v149
    v_cvt_pk_bf16_f32 v145, v150, v151
    v_mfma_f32_16x16x32_bf16 v[148:151], v[64:67], v[140:143], 0
    v_exp_f32 v152, v152
    v_mov_b32 v147, 0
    v_cvt_pk_bf16_f32 v146, v152, 0
    v_mfma_f32_16x16x32_bf16 v[152:155], v[72:75], v[140:143], 0
    v_cvt_pk_bf16_f32 v200, v200, v201
    v_cvt_pk_bf16_f32 v201, v202, v203
    v_mfma_f32_16x16x32_bf16 v[168:171], v[88:91], v[144:147], v[168:171]
    s_waitcnt lgkmcnt(0)
    s_barrier
    ds_read_b128 v[228:231], v236 offset:0
    v_mfma_f32_16x16x32_bf16 v[148:151], v[68:71], v[144:147], v[148:151]
    ds_read_b128 v[232:235], v236 offset:1024
    ds_read_b128 v[212:215], v249 offset:30720
    v_mfma_f32_16x16x32_bf16 v[152:155], v[76:79], v[144:147], v[152:155]
    ds_read_b128 v[216:219], v249 offset:31744
    ds_read_b128 v[220:223], v249 offset:32768
    v_mfma_f32_16x16x32_bf16 v[164:167], v[84:87], v[144:147], v[164:167]
    s_nop 0
    v_rcp_f32 v168, v168
    s_nop 0
    v_mul_f32 v148, v148, v168
    v_mul_f32 v149, v149, v168
    v_mul_f32 v150, v150, v168
    v_mul_f32 v151, v151, v168
    v_cvt_pk_bf16_f32 v148, v148, v149
    v_mul_f32 v164, v164, v168
    v_mul_f32 v165, v165, v168
    v_mul_f32 v152, v152, v168
    v_mul_f32 v153, v153, v168
    v_mul_f32 v154, v154, v168
    v_mul_f32 v155, v155, v168
    v_mul_f32 v166, v166, v168
    v_mul_f32 v167, v167, v168
    v_cvt_pk_bf16_f32 v149, v150, v151
    v_cvt_pk_bf16_f32 v164, v164, v165
    v_cvt_pk_bf16_f32 v150, v152, v153
    s_waitcnt lgkmcnt(4)
    buffer_store_dwordx4 v[228:231], v244, s[32:35], s43 offen sc0 sc1
    s_waitcnt lgkmcnt(3)
    s_mov_b64 exec, s[54:55]
    buffer_store_dwordx4 v[232:235], v245, s[32:35], s43 offen sc0 sc1
    s_mov_b64 exec, -1
    s_waitcnt lgkmcnt(2)
    v_mfma_f32_16x16x32_bf16 v[188:191], a[240:243], v[212:215], 0
    ds_read_b128 v[228:231], v249 offset:4096
    ds_read_b128 v[232:235], v249 offset:5120
    v_mfma_f32_16x16x32_bf16 v[192:195], v[100:103], v[212:215], 0
    v_cvt_pk_bf16_f32 v151, v154, v155
    s_waitcnt lgkmcnt(3)
    v_mfma_f32_16x16x32_bf16 v[188:191], a[244:247], v[216:219], v[188:191]
    v_cvt_pk_bf16_f32 v165, v166, v167
    v_cvt_pk_bf16_f32 v202, v204, v205
    v_mfma_f32_16x16x32_bf16 v[192:195], v[104:107], v[216:219], v[192:195]
    ds_read_b128 v[224:227], v249 offset:33792
    s_waitcnt lgkmcnt(3)
    v_mfma_f32_16x16x32_bf16 v[188:191], a[248:251], v[220:223], v[188:191]
    v_cvt_pk_bf16_f32 v203, v206, v207
    v_cvt_pk_bf16_f32 v204, v208, v209
    v_mfma_f32_16x16x32_bf16 v[192:195], v[108:111], v[220:223], v[192:195]
    buffer_store_dwordx4 v[184:187], v243, s[32:35], s43 offen sc0 sc1
    s_nop 0
    s_nop 0
    v_mfma_f32_16x16x32_bf16 v[184:187], a[216:219], v[212:215], 0
    v_cvt_pk_bf16_f32 v205, v210, v211
    v_cndmask_b32 v255, 0, v240, s[80:81]
    v_mfma_f32_16x16x32_bf16 v[184:187], a[220:223], v[216:219], v[184:187]
    v_sub_u32 v255, 8064, v255
    s_waitcnt lgkmcnt(2)
    v_mfma_f32_16x16x32_bf16 v[172:175], a[232:235], v[228:231], v[172:175]
    v_add_u32 v242, v242, v255
    v_cndmask_b32 v255, 0, v240, s[84:85]
    v_mfma_f32_16x16x32_bf16 v[176:179], v[92:95], v[228:231], v[176:179]
    s_waitcnt lgkmcnt(1)
    v_sub_u32 v255, 8064, v255
    v_add_u32 v243, v243, v255
    v_mfma_f32_16x16x32_bf16 v[180:183], v[116:119], v[228:231], v[180:183]
    ds_read_b128 v[228:231], v249 offset:34816
    v_add_u32 v244, v244, v239
    v_mfma_f32_16x16x32_bf16 v[172:175], a[236:239], v[232:235], v[172:175]
    v_bfe_u32 v239, v253, 6, 1
    v_mul_u32_u24 v239, s74, v239
    v_mfma_f32_16x16x32_bf16 v[176:179], v[96:99], v[232:235], v[176:179]
    v_mbcnt_lo_u32_b32 v255, -1, 0
    v_sub_u32 v239, 8064, v239
    v_mfma_f32_16x16x32_bf16 v[180:183], v[120:123], v[232:235], v[180:183]
    ds_write_b128 v251, v[148:151] offset:36864
    ds_write_b64 v252, v[164:165] offset:36864
    v_mfma_f32_16x16x32_bf16 v[184:187], a[224:227], v[220:223], v[184:187]
    s_waitcnt lgkmcnt(3)
    ds_read_b128 v[232:235], v249 offset:35840
    v_mbcnt_hi_u32_b32 v255, -1, v255
    v_mfma_f32_16x16x32_bf16 v[184:187], a[228:231], v[224:227], v[184:187]
    v_add_u32 v245, v245, v239
    v_lshrrev_b32 v240, 4, v255
    v_mfma_f32_16x16x32_bf16 v[188:191], a[252:255], v[224:227], v[188:191]
    v_and_b32 v239, 15, v255
    v_lshrrev_b32 v255, 2, v239
    v_mfma_f32_16x16x32_bf16 v[192:195], v[112:115], v[224:227], v[192:195]
    s_waitcnt lgkmcnt(3)
    buffer_store_dwordx4 v[200:203], v241, s[32:35], 0 offen sc0 sc1
    v_mfma_f32_16x16x32_bf16 v[184:187], a[232:235], v[228:231], v[184:187]
    ds_write_b64 v246, v[204:205] offset:6144
    v_mfma_f32_16x16x32_bf16 v[188:191], v[92:95], v[228:231], v[188:191]
    v_cmp_eq_u32 vcc, 3, v255
    v_mul_u32_u24 v237, 2688, v255
    v_mfma_f32_16x16x32_bf16 v[192:195], v[116:119], v[228:231], v[192:195]
    v_cndmask_b32 v254, 0, v254, vcc
    v_add_u32 v237, s78, v237
    v_sub_u32 v237, v237, v254
    v_lshl_add_u32 v238, v240, 3, v237
    v_lshl_add_u32 v237, v240, 4, v237
    v_add_u32 v238, s83, v238
    v_add_u32 v237, s82, v237
    v_cvt_pk_bf16_f32 v172, v172, v173
    v_cvt_pk_bf16_f32 v173, v174, v175
    v_cvt_pk_bf16_f32 v174, v176, v177
    v_cvt_pk_bf16_f32 v175, v178, v179
    v_cvt_pk_bf16_f32 v176, v180, v181
    v_cvt_pk_bf16_f32 v177, v182, v183
    s_waitcnt lgkmcnt(2)
    s_barrier
    ds_read_b128 v[212:215], v249 offset:36864
    s_waitcnt lgkmcnt(2)
    v_mfma_f32_16x16x32_bf16 v[184:187], a[236:239], v[232:235], v[184:187]
    ds_read_b128 v[216:219], v249 offset:37888
    ds_read_b128 v[220:223], v249 offset:38912
    v_mfma_f32_16x16x32_bf16 v[188:191], v[96:99], v[232:235], v[188:191]
    ds_read_b128 v[224:227], v249 offset:39936
    ds_read_b128 v[228:231], v249 offset:40960
    v_mfma_f32_16x16x32_bf16 v[192:195], v[120:123], v[232:235], v[192:195]
    ds_read_b128 v[232:235], v249 offset:41984
    s_mov_b64 exec, s[72:73]
    buffer_store_dwordx4 v[172:175], v237, s[32:35], 0 offen sc0 sc1
    buffer_store_dwordx2 v[176:177], v238, s[32:35], 0 offen
    s_mov_b64 exec, -1
    v_cvt_pk_bf16_f32 v184, v184, v185
    v_cvt_pk_bf16_f32 v185, v186, v187
    v_cvt_pk_bf16_f32 v186, v188, v189
    v_cvt_pk_bf16_f32 v188, v192, v193
    v_cvt_pk_bf16_f32 v189, v194, v195
    v_cvt_pk_bf16_f32 v187, v190, v191
    s_waitcnt lgkmcnt(5)
    v_mfma_f32_16x16x32_bf16 v[200:203], a[216:219], v[212:215], 0
    v_mfma_f32_16x16x32_bf16 v[204:207], a[240:243], v[212:215], 0
    s_waitcnt lgkmcnt(4)
    v_mfma_f32_16x16x32_bf16 v[208:211], v[100:103], v[212:215], 0
    v_mfma_f32_16x16x32_bf16 v[200:203], a[220:223], v[216:219], v[200:203]
    s_waitcnt lgkmcnt(3)
    v_mfma_f32_16x16x32_bf16 v[204:207], a[244:247], v[216:219], v[204:207]
    v_mfma_f32_16x16x32_bf16 v[208:211], v[104:107], v[216:219], v[208:211]
    v_mfma_f32_16x16x32_bf16 v[200:203], a[224:227], v[220:223], v[200:203]
    s_waitcnt lgkmcnt(2)
    v_mfma_f32_16x16x32_bf16 v[204:207], a[248:251], v[220:223], v[204:207]
    v_mfma_f32_16x16x32_bf16 v[208:211], v[108:111], v[220:223], v[208:211]
    v_mfma_f32_16x16x32_bf16 v[200:203], a[228:231], v[224:227], v[200:203]
    s_waitcnt lgkmcnt(1)
    v_mfma_f32_16x16x32_bf16 v[204:207], a[252:255], v[224:227], v[204:207]
    v_mfma_f32_16x16x32_bf16 v[208:211], v[112:115], v[224:227], v[208:211]
    v_mfma_f32_16x16x32_bf16 v[200:203], a[232:235], v[228:231], v[200:203]
    s_waitcnt lgkmcnt(0)
    v_mfma_f32_16x16x32_bf16 v[204:207], v[92:95], v[228:231], v[204:207]
    v_mfma_f32_16x16x32_bf16 v[208:211], v[116:119], v[228:231], v[208:211]
    v_mfma_f32_16x16x32_bf16 v[200:203], a[236:239], v[232:235], v[200:203]
    s_nop 0
    v_mfma_f32_16x16x32_bf16 v[204:207], v[96:99], v[232:235], v[204:207]
    s_nop 0
    v_mfma_f32_16x16x32_bf16 v[208:211], v[120:123], v[232:235], v[208:211]
    s_nop 0
    ds_write_b64 v246, v[188:189] offset:8192
    s_nop 0
    s_nop 0
    v_cvt_pk_bf16_f32 v200, v200, v201
    v_cvt_pk_bf16_f32 v201, v202, v203
    v_cvt_pk_bf16_f32 v202, v204, v205
    v_cvt_pk_bf16_f32 v203, v206, v207
    v_cvt_pk_bf16_f32 v204, v208, v209
    v_cvt_pk_bf16_f32 v205, v210, v211
    ds_write_b64 v246, v[204:205] offset:10240
    buffer_store_dwordx4 v[184:187], v242, s[32:35], 0 offen sc0 sc1
    buffer_store_dwordx4 v[200:203], v243, s[32:35], 0 offen sc0 sc1
    s_waitcnt lgkmcnt(0)
    s_barrier
    ds_read_b128 v[212:215], v236 offset:6144
    ds_read_b128 v[216:219], v236 offset:7168
    s_waitcnt lgkmcnt(1)
    buffer_store_dwordx4 v[212:215], v244, s[32:35], 0 offen sc0 sc1
    s_waitcnt lgkmcnt(0)
    s_mov_b64 exec, s[54:55]
    buffer_store_dwordx4 v[216:219], v245, s[32:35], 0 offen sc0 sc1
    s_mov_b64 exec, -1
L_end:
    s_endpgm
.section .rodata,"a"
.p2align 6
.amdhsa_kernel standalone__window_attn_swin__vision_kernel
  .amdhsa_next_free_vgpr 512
  .amdhsa_next_free_sgpr 102
  .amdhsa_accum_offset 256
  .amdhsa_group_segment_fixed_size 0
  .amdhsa_kernarg_size 72
  .amdhsa_user_sgpr_count 2
  .amdhsa_user_sgpr_kernarg_segment_ptr 1
  .amdhsa_system_sgpr_workgroup_id_x 1
.end_amdhsa_kernel
```
